```python
import torch

def _softmax(x, axis=-1):
    return torch.softmax(x, dim=axis)
def _gelu(x):
    return torch.nn.functional.gelu(x, approximate="tanh")
def _silu(x):
    return torch.nn.functional.silu(x)
def _sigmoid(x):
    return torch.sigmoid(x)
def _layernorm(x, axis=-1, eps=1e-5):
    m = x.mean(dim=axis, keepdim=True)
    v = x.var(dim=axis, keepdim=True, unbiased=False)
    return (x - m) / torch.sqrt(v + eps)
def _scatter_add(tgt, idx, src, axis=0):
    return tgt.clone().index_add_(axis, idx, src)
def _segment_sum(src, seg, n):
    out = torch.zeros((n,) + src.shape[1:], dtype=src.dtype)
    return out.index_add_(0, seg, src)
def _pad(x, pw):
    flat = tuple(v for pair in reversed(pw) for v in pair)
    return torch.nn.functional.pad(x, flat)

kernel_name = 'standalone__dense_activation_relu__prompt'

def setup_inputs():

    _w = (lambda a: (lambda t: t.to(torch.bfloat16) if t.is_floating_point() else t)(torch.as_tensor(a)))
    B, S, D, Dff = 1, 2048, 640, 1728
    return {
        "x": _w((lambda *s: torch.randn(*s, dtype=torch.bfloat16) * 0.05)(B, S, D)),
        "w1": _w((lambda *s: torch.randn(*s, dtype=torch.bfloat16) * 0.05)(D, Dff)),
        "w2": _w((lambda *s: torch.randn(*s, dtype=torch.bfloat16) * 0.05)(Dff, D)),
    }

def reference(x, w1, w2):
    h = torch.einsum("bsd,df->bsf", x, w1)
    zero = torch.zeros_like(h)
    h = torch.maximum(h, zero)
    return torch.einsum("bsf,fd->bsd", h, w2)
```

```asm
; @launch grid=(256,1,1) block=(256,1,1) lds=163840
.amdgcn_target "amdgcn-amd-amdhsa--gfx950"
.text
.globl standalone__dense_activation_relu__prompt_kernel
.p2align 8
.type standalone__dense_activation_relu__prompt_kernel,@function
standalone__dense_activation_relu__prompt_kernel:
    s_cmp_ge_u32 s2, 256
    s_cbranch_scc1 Lexit
    s_load_dwordx8 s[4:11], s[0:1], 0
    s_load_dwordx4 s[12:15], s[0:1], 32
    v_lshrrev_b32 v1, 6, v0
    v_and_b32 v2, 63, v0
    s_nop 0
    v_readfirstlane_b32 s36, v1
    s_and_b32 s53, s2, 7
    s_lshr_b32 s54, s2, 3
    s_cmp_ge_u32 s54, 28
    s_cbranch_scc1 Lidle
    s_mul_i32 s55, s54, 37
    s_lshr_b32 s55, s55, 8
    s_mul_i32 s56, s55, 7
    s_sub_u32 s56, s54, s56
    s_mul_i32 s39, s56, 3
    s_mul_i32 s57, s55, 5
    s_lshr_b32 s57, s57, 1
    s_add_u32 s39, s39, s57
    s_cmp_ge_u32 s39, 10
    s_cselect_b32 s57, 10, 0
    s_sub_u32 s39, s39, s57
    s_cmp_ge_u32 s39, 10
    s_cselect_b32 s57, 10, 0
    s_sub_u32 s39, s39, s57
    s_lshr_b32 s57, s53, 1
    s_lshl_b32 s57, s57, 2
    s_add_u32 s55, s55, s57
    s_and_b32 s57, s53, 1
    s_mul_i32 s57, s57, 7
    s_add_u32 s56, s56, s57
    s_lshl_b32 s57, s56, 7
    s_min_u32 s57, s57, 1600
    v_lshrrev_b32 v12, 3, v2
    v_mul_u32_u24 v12, 1280, v12
    v_lshrrev_b32 v13, 4, v2
    v_and_b32 v14, 7, v2
    v_xor_b32 v14, v14, v13
    v_xor_b32 v15, 0, v14
    v_lshlrev_b32 v15, 4, v15
    v_add_u32 v15, v15, v12
    v_add_u32 v3, 0, v15
    v_xor_b32 v15, 4, v14
    v_lshlrev_b32 v15, 4, v15
    v_add_u32 v15, v15, v12
    v_add_u32 v4, 9216, v15
    v_xor_b32 v15, 0, v14
    v_lshlrev_b32 v15, 4, v15
    v_add_u32 v15, v15, v12
    v_add_u32 v5, 18432, v15
    v_xor_b32 v15, 4, v14
    v_lshlrev_b32 v15, 4, v15
    v_add_u32 v15, v15, v12
    v_add_u32 v6, 27648, v15
    v_mul_u32_u24 v12, 3456, v13
    v_and_b32 v14, 15, v2
    v_lshrrev_b32 v14, 1, v14
    v_xor_b32 v14, v14, v13
    v_and_b32 v16, 1, v2
    v_xor_b32 v15, 0, v14
    v_lshlrev_b32 v15, 1, v15
    v_or_b32 v15, v15, v16
    v_lshlrev_b32 v15, 4, v15
    v_add_u32 v15, v15, v12
    v_add_u32 v7, 0, v15
    v_xor_b32 v15, 0, v14
    v_lshlrev_b32 v15, 1, v15
    v_or_b32 v15, v15, v16
    v_lshlrev_b32 v15, 4, v15
    v_add_u32 v15, v15, v12
    v_add_u32 v8, 12800, v15
    v_xor_b32 v15, 4, v14
    v_lshlrev_b32 v15, 1, v15
    v_or_b32 v15, v15, v16
    v_lshlrev_b32 v15, 4, v15
    v_add_u32 v15, v15, v12
    v_add_u32 v9, 25600, v15
    v_xor_b32 v15, 4, v14
    v_lshlrev_b32 v15, 1, v15
    v_or_b32 v15, v15, v16
    v_lshlrev_b32 v15, 4, v15
    v_add_u32 v15, v15, v12
    v_add_u32 v10, 38400, v15
    s_lshl_b32 s37, s55, 2
    s_add_u32 s37, s37, s36
    s_mul_i32 s37, s37, 40960
    s_mul_i32 s38, s36, 55296
    s_lshl_b32 s42, s57, 1
    s_add_u32 s38, s38, s42
    s_lshl_b32 s42, s36, 12
    s_waitcnt lgkmcnt(0)
    s_mov_b32 s16, s4
    s_and_b32 s17, s5, 0xffff
    s_mov_b32 s18, 2621440
    s_mov_b32 s19, 0x00020000
    s_mov_b32 s20, s6
    s_and_b32 s21, s7, 0xffff
    s_mov_b32 s22, 2211840
    s_mov_b32 s23, 0x00020000
    s_lshl_b32 s40, s39, 7
    s_add_u32 s40, s40, s37
    s_add_u32 m0, s42, 0
    s_mul_i32 s41, s39, 221184
    buffer_load_dwordx4 v3, s[16:19], s40 offen offset:0 lds
    buffer_load_dwordx4 v4, s[16:19], s40 offen offset:1024 lds
    buffer_load_dwordx4 v5, s[16:19], s40 offen offset:2048 lds
    buffer_load_dwordx4 v6, s[16:19], s40 offen offset:3072 lds
    s_add_u32 s41, s41, s38
    s_add_u32 m0, s42, 16384
    s_add_u32 s39, s39, 1
    s_cmp_eq_u32 s39, 10
    s_cselect_b32 s39, 0, s39
    buffer_load_dwordx4 v7, s[20:23], s41 offen offset:0 lds
    buffer_load_dwordx4 v8, s[20:23], s41 offen offset:1024 lds
    buffer_load_dwordx4 v9, s[20:23], s41 offen offset:2048 lds
    buffer_load_dwordx4 v10, s[20:23], s41 offen offset:3072 lds
    s_lshl_b32 s40, s39, 7
    s_add_u32 s40, s40, s37
    s_add_u32 m0, s42, 32768
    s_mul_i32 s41, s39, 221184
    buffer_load_dwordx4 v3, s[16:19], s40 offen offset:0 lds
    buffer_load_dwordx4 v4, s[16:19], s40 offen offset:1024 lds
    buffer_load_dwordx4 v5, s[16:19], s40 offen offset:2048 lds
    buffer_load_dwordx4 v6, s[16:19], s40 offen offset:3072 lds
    s_add_u32 s41, s41, s38
    s_add_u32 m0, s42, 49152
    s_add_u32 s39, s39, 1
    s_cmp_eq_u32 s39, 10
    s_cselect_b32 s39, 0, s39
    buffer_load_dwordx4 v7, s[20:23], s41 offen offset:0 lds
    buffer_load_dwordx4 v8, s[20:23], s41 offen offset:1024 lds
    buffer_load_dwordx4 v9, s[20:23], s41 offen offset:2048 lds
    buffer_load_dwordx4 v10, s[20:23], s41 offen offset:3072 lds
    s_mov_b32 s24, s14
    s_and_b32 s25, s15, 0xffff
    s_mov_b32 s26, 8421376
    s_mov_b32 s27, 0x00020000
    s_mov_b32 s28, s10
    s_and_b32 s29, s11, 0xffff
    s_mov_b32 s30, 2621440
    s_mov_b32 s31, 0x00020000
    s_mov_b32 s32, s12
    s_and_b32 s33, s13, 0xffff
    s_mov_b32 s34, 256
    s_mov_b32 s35, 0x00020000
    s_mov_b32 s96, s8
    s_and_b32 s97, s9, 0xffff
    s_mov_b32 s98, 2211840
    s_mov_b32 s99, 0x00020000
    s_lshr_b32 s58, s36, 1
    s_and_b32 s59, s36, 1
    v_and_b32 v12, 15, v2
    v_lshrrev_b32 v14, 1, v12
    v_xor_b32 v14, v14, v13
    v_lshlrev_b32 v14, 4, v14
    v_lshlrev_b32 v12, 7, v12
    v_add_u32 v12, v12, v14
    s_lshl_b32 s51, s58, 13
    v_add_u32 v22, s51, v12
    v_xor_b32 v23, 64, v22
    v_bfe_u32 v12, v2, 2, 2
    v_lshlrev_b32 v14, 3, v13
    v_add_u32 v14, v14, v12
    v_lshlrev_b32 v14, 8, v14
    v_and_b32 v15, 1, v13
    v_lshlrev_b32 v15, 2, v15
    v_or_b32 v15, v15, v12
    v_and_b32 v16, 3, v2
    v_lshlrev_b32 v16, 3, v16
    v_add_u32 v14, v14, v16
    v_add_u32 v14, 16384, v14
    s_lshl_b32 s51, s59, 2
    s_add_u32 s52, s51, 0
    v_xor_b32 v16, s52, v15
    v_lshlrev_b32 v16, 5, v16
    v_add_u32 v24, v14, v16
    s_add_u32 s52, s51, 1
    v_xor_b32 v16, s52, v15
    v_lshlrev_b32 v16, 5, v16
    v_add_u32 v25, v14, v16
    s_add_u32 s52, s51, 2
    v_xor_b32 v16, s52, v15
    v_lshlrev_b32 v16, 5, v16
    v_add_u32 v26, v14, v16
    s_add_u32 s52, s51, 3
    v_xor_b32 v16, s52, v15
    v_lshlrev_b32 v16, 5, v16
    v_add_u32 v27, v14, v16
    v_add_u32 v160, 0x10000, v22
    v_add_u32 v161, 0x10000, v23
    v_add_u32 v162, 0x10000, v24
    v_add_u32 v163, 0x10000, v25
    v_add_u32 v164, 0x10000, v26
    v_add_u32 v165, 0x10000, v27
    s_lshl_b32 s51, s55, 3
    s_lshl_b32 s52, s58, 2
    s_add_u32 s51, s51, s52
    s_mul_i32 s51, s51, 55296
    s_lshr_b32 s52, s57, 5
    s_lshl_b32 s43, s59, 1
    s_add_u32 s52, s52, s43
    s_lshl_b32 s52, s52, 10
    s_add_u32 s51, s51, s52
    v_lshlrev_b32 v18, 4, v2
    v_add_u32 v18, s51, v18
    s_lshl_b32 s51, s56, 1
    s_add_u32 s51, s51, s59
    s_cmp_eq_u32 s51, 26
    s_cselect_b32 s43, 1073741824, 0
    s_mul_i32 s52, s55, 14
    s_add_u32 s52, s52, s56
    s_lshl_b32 s52, s52, 5
    s_add_u32 s52, s52, s36
    s_lshl_b32 s52, s52, 2
    s_add_u32 s44, s52, 8388608
    s_mul_i32 s51, s53, 55
    s_add_u32 s52, s51, 55
    s_lshr_b32 s51, s51, 1
    s_lshr_b32 s52, s52, 1
    s_add_u32 s51, s51, s54
    s_cmp_lt_u32 s51, s52
    s_cselect_b32 s101, 1, 0
    s_min_u32 s51, s51, 219
    s_mul_i32 s55, s51, 205
    s_lshr_b32 s55, s55, 11
    s_mul_i32 s56, s55, 10
    s_sub_u32 s56, s51, s56
    s_mul_i32 s57, s55, 5
    s_cmp_ge_u32 s55, 5
    s_cselect_b32 s58, 6, 0
    s_add_u32 s57, s57, s58
    s_cmp_ge_u32 s55, 11
    s_cselect_b32 s58, 6, 0
    s_add_u32 s57, s57, s58
    s_cmp_ge_u32 s55, 17
    s_cselect_b32 s58, 6, 0
    s_add_u32 s57, s57, s58
    s_mul_i32 s46, s57, 54
    s_add_u32 s46, s46, s36
    s_lshl_b32 s46, s46, 10
    s_mul_i32 s45, s36, 40960
    s_lshl_b32 s58, s56, 7
    s_add_u32 s45, s45, s58
    s_cmp_lt_u32 s36, 2
    s_cselect_b32 s50, 0, 1073741824
    s_cselect_b32 s3, 0, -163840
    s_mul_i32 s48, s56, 1435
    s_lshr_b32 s48, s48, 10
    s_mul_i32 s58, s55, 5
    s_add_u32 s48, s48, s58
    s_mul_i32 s58, s48, 4682
    s_lshr_b32 s58, s58, 16
    s_mul_i32 s58, s58, 14
    s_sub_u32 s48, s48, s58
    s_mov_b32 s47, s48
    s_lshl_b32 s100, s36, 14
    s_add_u32 s100, s100, 98304
    s_mul_i32 s53, s36, 24576
    s_cmp_eq_u32 s36, 0
    s_cselect_b32 s54, 0, 1073741824
    v_lshlrev_b32 v17, 4, v2
    v_mov_b32 v166, v17
    v_add_u32 v167, 55296, v17
    v_add_u32 v168, 110592, v17
    v_add_u32 v169, 165888, v17
    v_add_u32 v170, 221184, v17
    v_lshrrev_b32 v12, 3, v2
    v_mul_u32_u24 v12, 1280, v12
    v_lshrrev_b32 v13, 4, v2
    v_bfe_u32 v14, v2, 1, 2
    v_xor_b32 v14, v14, v13
    v_lshlrev_b32 v14, 1, v14
    v_and_b32 v15, 1, v2
    v_or_b32 v14, v14, v15
    v_lshlrev_b32 v14, 4, v14
    v_add_u32 v181, v12, v14
    v_add_u32 v182, 9216, v181
    v_add_u32 v183, 18432, v181
    v_add_u32 v184, 27648, v181
    v_lshrrev_b32 v12, 2, v2
    v_lshlrev_b32 v12, 7, v12
    v_and_b32 v14, 3, v2
    v_lshlrev_b32 v14, 3, v14
    v_add_u32 v12, v12, v14
    v_bfe_u32 v13, v2, 3, 2
    s_add_u32 s58, s36, 0
    s_and_b32 s58, s58, 3
    v_xor_b32 v14, s58, v13
    v_lshlrev_b32 v14, 5, v14
    v_add_u32 v14, v12, v14
    v_add_u32 v185, s100, v14
    v_add_u32 v252, s53, v14
    s_add_u32 s58, s36, 1
    s_and_b32 s58, s58, 3
    v_xor_b32 v14, s58, v13
    v_lshlrev_b32 v14, 5, v14
    v_add_u32 v14, v12, v14
    v_add_u32 v186, s100, v14
    v_add_u32 v253, s53, v14
    s_mul_i32 s59, s58, 15360
    s_add_u32 s59, s59, 0
    v_add_u32 v174, s59, v17
    s_add_u32 s58, s36, 2
    s_and_b32 s58, s58, 3
    v_xor_b32 v14, s58, v13
    v_lshlrev_b32 v14, 5, v14
    v_add_u32 v14, v12, v14
    v_add_u32 v187, s100, v14
    v_add_u32 v254, s53, v14
    s_mul_i32 s59, s58, 15360
    s_add_u32 s59, s59, 5120
    v_add_u32 v175, s59, v17
    s_add_u32 s58, s36, 3
    s_and_b32 s58, s58, 3
    v_xor_b32 v14, s58, v13
    v_lshlrev_b32 v14, 5, v14
    v_add_u32 v14, v12, v14
    v_add_u32 v188, s100, v14
    v_add_u32 v255, s53, v14
    s_mul_i32 s59, s58, 15360
    s_add_u32 s59, s59, 10240
    v_add_u32 v176, s59, v17
    s_mul_i32 s59, s36, 15360
    v_add_u32 v177, s59, v17
    s_lshr_b32 s59, s57, 3
    s_add_u32 s58, s57, 4
    s_lshr_b32 s58, s58, 3
    s_cmp_eq_u32 s58, s59
    s_cselect_b32 s58, 13, 27
    s_mul_i32 s59, s59, 14
    v_min_u32 v12, s58, v2
    v_add_u32 v12, s59, v12
    v_lshlrev_b32 v12, 7, v12
    v_add_u32 v172, 8388608, v12
    s_lshl_b32 s59, s57, 4
    v_and_b32 v178, 15, v2
    v_add_u32 v178, s59, v178
    v_mul_u32_u24 v178, 1280, v178
    v_lshrrev_b32 v11, 4, v2
    v_lshlrev_b32 v11, 3, v11
    v_add_u32 v178, v178, v11
    s_lshl_b32 s59, s56, 7
    s_lshl_b32 s58, s36, 5
    s_add_u32 s59, s59, s58
    v_add_u32 v178, s59, v178
    v_mov_b32 v179, 1
    v_mov_b32 v180, 0
    s_waitcnt vmcnt(8)
    s_barrier
    ds_read_b64_tr_b16 v[112:113], v24 offset:0
    ds_read_b64_tr_b16 v[114:115], v24 offset:1024
    ds_read_b128 v[96:99], v22 offset:0
    ds_read_b64_tr_b16 v[116:117], v25 offset:0
    ds_read_b64_tr_b16 v[118:119], v25 offset:1024
    ds_read_b128 v[100:103], v22 offset:2048
    ds_read_b64_tr_b16 v[120:121], v26 offset:0
    ds_read_b64_tr_b16 v[122:123], v26 offset:1024
    ds_read_b128 v[104:107], v22 offset:4096
    ds_read_b64_tr_b16 v[124:125], v27 offset:0
    ds_read_b64_tr_b16 v[126:127], v27 offset:1024
    ds_read_b128 v[108:111], v22 offset:6144
    s_waitcnt lgkmcnt(0)
    s_lshl_b32 s40, s39, 7
    s_add_u32 s40, s40, s37
    s_add_u32 m0, s42, 65536
    s_mul_i32 s41, s39, 221184
    v_mfma_f32_16x16x32_bf16 v[32:35], v[112:115], v[96:99], 0
    ds_read_b64_tr_b16 v[144:145], v24 offset:8192
    v_mfma_f32_16x16x32_bf16 v[36:39], v[112:115], v[100:103], 0
    ds_read_b64_tr_b16 v[146:147], v24 offset:9216
    buffer_load_dwordx4 v3, s[16:19], s40 offen offset:0 lds
    v_mfma_f32_16x16x32_bf16 v[40:43], v[112:115], v[104:107], 0
    ds_read_b128 v[128:131], v23 offset:0
    v_mfma_f32_16x16x32_bf16 v[44:47], v[112:115], v[108:111], 0
    ds_read_b64_tr_b16 v[148:149], v25 offset:8192
    buffer_load_dwordx4 v4, s[16:19], s40 offen offset:1024 lds
    v_mfma_f32_16x16x32_bf16 v[48:51], v[116:119], v[96:99], 0
    ds_read_b64_tr_b16 v[150:151], v25 offset:9216
    v_mfma_f32_16x16x32_bf16 v[52:55], v[116:119], v[100:103], 0
    ds_read_b128 v[132:135], v23 offset:2048
    buffer_load_dwordx4 v5, s[16:19], s40 offen offset:2048 lds
    v_mfma_f32_16x16x32_bf16 v[56:59], v[116:119], v[104:107], 0
    ds_read_b64_tr_b16 v[152:153], v26 offset:8192
    v_mfma_f32_16x16x32_bf16 v[60:63], v[116:119], v[108:111], 0
    ds_read_b64_tr_b16 v[154:155], v26 offset:9216
    buffer_load_dwordx4 v6, s[16:19], s40 offen offset:3072 lds
    v_mfma_f32_16x16x32_bf16 v[64:67], v[120:123], v[96:99], 0
    ds_read_b128 v[136:139], v23 offset:4096
    v_mfma_f32_16x16x32_bf16 v[68:71], v[120:123], v[100:103], 0
    ds_read_b64_tr_b16 v[156:157], v27 offset:8192
    s_add_u32 s41, s41, s38
    s_add_u32 m0, s42, 81920
    s_add_u32 s39, s39, 1
    s_cmp_eq_u32 s39, 10
    s_cselect_b32 s39, 0, s39
    buffer_load_dwordx4 v7, s[20:23], s41 offen offset:0 lds
    v_mfma_f32_16x16x32_bf16 v[72:75], v[120:123], v[104:107], 0
    ds_read_b64_tr_b16 v[158:159], v27 offset:9216
    v_mfma_f32_16x16x32_bf16 v[76:79], v[120:123], v[108:111], 0
    ds_read_b128 v[140:143], v23 offset:6144
    buffer_load_dwordx4 v8, s[20:23], s41 offen offset:1024 lds
    v_mfma_f32_16x16x32_bf16 v[80:83], v[124:127], v[96:99], 0
    v_mfma_f32_16x16x32_bf16 v[84:87], v[124:127], v[100:103], 0
    buffer_load_dwordx4 v9, s[20:23], s41 offen offset:2048 lds
    v_mfma_f32_16x16x32_bf16 v[88:91], v[124:127], v[104:107], 0
    v_mfma_f32_16x16x32_bf16 v[92:95], v[124:127], v[108:111], 0
    buffer_load_dwordx4 v10, s[20:23], s41 offen offset:3072 lds
    s_waitcnt vmcnt(8) lgkmcnt(0)
    s_barrier
    s_lshl_b32 s40, s39, 7
    s_add_u32 s40, s40, s37
    s_add_u32 m0, s42, 0
    s_mul_i32 s41, s39, 221184
    v_mfma_f32_16x16x32_bf16 v[32:35], v[144:147], v[128:131], v[32:35]
    ds_read_b64_tr_b16 v[112:113], v24 offset:32768
    v_mfma_f32_16x16x32_bf16 v[36:39], v[144:147], v[132:135], v[36:39]
    ds_read_b64_tr_b16 v[114:115], v24 offset:33792
    buffer_load_dwordx4 v3, s[16:19], s40 offen offset:0 lds
    v_mfma_f32_16x16x32_bf16 v[40:43], v[144:147], v[136:139], v[40:43]
    ds_read_b128 v[96:99], v22 offset:32768
    v_mfma_f32_16x16x32_bf16 v[44:47], v[144:147], v[140:143], v[44:47]
    ds_read_b64_tr_b16 v[116:117], v25 offset:32768
    v_mfma_f32_16x16x32_bf16 v[48:51], v[148:151], v[128:131], v[48:51]
    ds_read_b64_tr_b16 v[118:119], v25 offset:33792
    v_mfma_f32_16x16x32_bf16 v[52:55], v[148:151], v[132:135], v[52:55]
    ds_read_b128 v[100:103], v22 offset:34816
    buffer_load_dwordx4 v4, s[16:19], s40 offen offset:1024 lds
    v_mfma_f32_16x16x32_bf16 v[56:59], v[148:151], v[136:139], v[56:59]
    ds_read_b64_tr_b16 v[120:121], v26 offset:32768
    v_mfma_f32_16x16x32_bf16 v[60:63], v[148:151], v[140:143], v[60:63]
    ds_read_b64_tr_b16 v[122:123], v26 offset:33792
    v_mfma_f32_16x16x32_bf16 v[64:67], v[152:155], v[128:131], v[64:67]
    ds_read_b128 v[104:107], v22 offset:36864
    v_mfma_f32_16x16x32_bf16 v[68:71], v[152:155], v[132:135], v[68:71]
    ds_read_b64_tr_b16 v[124:125], v27 offset:32768
    buffer_load_dwordx4 v5, s[16:19], s40 offen offset:2048 lds
    v_mfma_f32_16x16x32_bf16 v[72:75], v[152:155], v[136:139], v[72:75]
    ds_read_b64_tr_b16 v[126:127], v27 offset:33792
    v_mfma_f32_16x16x32_bf16 v[76:79], v[152:155], v[140:143], v[76:79]
    ds_read_b128 v[108:111], v22 offset:38912
    v_mfma_f32_16x16x32_bf16 v[80:83], v[156:159], v[128:131], v[80:83]
    v_mfma_f32_16x16x32_bf16 v[84:87], v[156:159], v[132:135], v[84:87]
    buffer_load_dwordx4 v6, s[16:19], s40 offen offset:3072 lds
    v_mfma_f32_16x16x32_bf16 v[88:91], v[156:159], v[136:139], v[88:91]
    v_mfma_f32_16x16x32_bf16 v[92:95], v[156:159], v[140:143], v[92:95]
    s_waitcnt lgkmcnt(0)
    s_add_u32 s41, s41, s38
    s_add_u32 m0, s42, 16384
    s_add_u32 s39, s39, 1
    s_cmp_eq_u32 s39, 10
    s_cselect_b32 s39, 0, s39
    v_mfma_f32_16x16x32_bf16 v[32:35], v[112:115], v[96:99], v[32:35]
    ds_read_b64_tr_b16 v[144:145], v24 offset:40960
    v_mfma_f32_16x16x32_bf16 v[36:39], v[112:115], v[100:103], v[36:39]
    ds_read_b64_tr_b16 v[146:147], v24 offset:41984
    buffer_load_dwordx4 v7, s[20:23], s41 offen offset:0 lds
    v_mfma_f32_16x16x32_bf16 v[40:43], v[112:115], v[104:107], v[40:43]
    ds_read_b128 v[128:131], v23 offset:32768
    v_mfma_f32_16x16x32_bf16 v[44:47], v[112:115], v[108:111], v[44:47]
    ds_read_b64_tr_b16 v[148:149], v25 offset:40960
    v_mfma_f32_16x16x32_bf16 v[48:51], v[116:119], v[96:99], v[48:51]
    ds_read_b64_tr_b16 v[150:151], v25 offset:41984
    v_mfma_f32_16x16x32_bf16 v[52:55], v[116:119], v[100:103], v[52:55]
    ds_read_b128 v[132:135], v23 offset:34816
    buffer_load_dwordx4 v8, s[20:23], s41 offen offset:1024 lds
    v_mfma_f32_16x16x32_bf16 v[56:59], v[116:119], v[104:107], v[56:59]
    ds_read_b64_tr_b16 v[152:153], v26 offset:40960
    v_mfma_f32_16x16x32_bf16 v[60:63], v[116:119], v[108:111], v[60:63]
    ds_read_b64_tr_b16 v[154:155], v26 offset:41984
    v_mfma_f32_16x16x32_bf16 v[64:67], v[120:123], v[96:99], v[64:67]
    ds_read_b128 v[136:139], v23 offset:36864
    v_mfma_f32_16x16x32_bf16 v[68:71], v[120:123], v[100:103], v[68:71]
    ds_read_b64_tr_b16 v[156:157], v27 offset:40960
    buffer_load_dwordx4 v9, s[20:23], s41 offen offset:2048 lds
    v_mfma_f32_16x16x32_bf16 v[72:75], v[120:123], v[104:107], v[72:75]
    ds_read_b64_tr_b16 v[158:159], v27 offset:41984
    v_mfma_f32_16x16x32_bf16 v[76:79], v[120:123], v[108:111], v[76:79]
    ds_read_b128 v[140:143], v23 offset:38912
    v_mfma_f32_16x16x32_bf16 v[80:83], v[124:127], v[96:99], v[80:83]
    v_mfma_f32_16x16x32_bf16 v[84:87], v[124:127], v[100:103], v[84:87]
    buffer_load_dwordx4 v10, s[20:23], s41 offen offset:3072 lds
    v_mfma_f32_16x16x32_bf16 v[88:91], v[124:127], v[104:107], v[88:91]
    v_mfma_f32_16x16x32_bf16 v[92:95], v[124:127], v[108:111], v[92:95]
    s_waitcnt vmcnt(8) lgkmcnt(0)
    s_barrier
    s_lshl_b32 s40, s39, 7
    s_add_u32 s40, s40, s37
    s_add_u32 m0, s42, 32768
    s_mul_i32 s41, s39, 221184
    v_mfma_f32_16x16x32_bf16 v[32:35], v[144:147], v[128:131], v[32:35]
    ds_read_b64_tr_b16 v[112:113], v162 offset:0
    v_mfma_f32_16x16x32_bf16 v[36:39], v[144:147], v[132:135], v[36:39]
    ds_read_b64_tr_b16 v[114:115], v162 offset:1024
    buffer_load_dwordx4 v3, s[16:19], s40 offen offset:0 lds
    v_mfma_f32_16x16x32_bf16 v[40:43], v[144:147], v[136:139], v[40:43]
    ds_read_b128 v[96:99], v160 offset:0
    v_mfma_f32_16x16x32_bf16 v[44:47], v[144:147], v[140:143], v[44:47]
    ds_read_b64_tr_b16 v[116:117], v163 offset:0
    v_mfma_f32_16x16x32_bf16 v[48:51], v[148:151], v[128:131], v[48:51]
    ds_read_b64_tr_b16 v[118:119], v163 offset:1024
    v_mfma_f32_16x16x32_bf16 v[52:55], v[148:151], v[132:135], v[52:55]
    ds_read_b128 v[100:103], v160 offset:2048
    buffer_load_dwordx4 v4, s[16:19], s40 offen offset:1024 lds
    v_mfma_f32_16x16x32_bf16 v[56:59], v[148:151], v[136:139], v[56:59]
    ds_read_b64_tr_b16 v[120:121], v164 offset:0
    v_mfma_f32_16x16x32_bf16 v[60:63], v[148:151], v[140:143], v[60:63]
    ds_read_b64_tr_b16 v[122:123], v164 offset:1024
    v_mfma_f32_16x16x32_bf16 v[64:67], v[152:155], v[128:131], v[64:67]
    ds_read_b128 v[104:107], v160 offset:4096
    v_mfma_f32_16x16x32_bf16 v[68:71], v[152:155], v[132:135], v[68:71]
    ds_read_b64_tr_b16 v[124:125], v165 offset:0
    buffer_load_dwordx4 v5, s[16:19], s40 offen offset:2048 lds
    v_mfma_f32_16x16x32_bf16 v[72:75], v[152:155], v[136:139], v[72:75]
    ds_read_b64_tr_b16 v[126:127], v165 offset:1024
    v_mfma_f32_16x16x32_bf16 v[76:79], v[152:155], v[140:143], v[76:79]
    ds_read_b128 v[108:111], v160 offset:6144
    v_mfma_f32_16x16x32_bf16 v[80:83], v[156:159], v[128:131], v[80:83]
    v_mfma_f32_16x16x32_bf16 v[84:87], v[156:159], v[132:135], v[84:87]
    buffer_load_dwordx4 v6, s[16:19], s40 offen offset:3072 lds
    v_mfma_f32_16x16x32_bf16 v[88:91], v[156:159], v[136:139], v[88:91]
    v_mfma_f32_16x16x32_bf16 v[92:95], v[156:159], v[140:143], v[92:95]
    s_waitcnt lgkmcnt(0)
    s_add_u32 s41, s41, s38
    s_add_u32 m0, s42, 49152
    s_add_u32 s39, s39, 1
    s_cmp_eq_u32 s39, 10
    s_cselect_b32 s39, 0, s39
    v_mfma_f32_16x16x32_bf16 v[32:35], v[112:115], v[96:99], v[32:35]
    ds_read_b64_tr_b16 v[144:145], v162 offset:8192
    v_mfma_f32_16x16x32_bf16 v[36:39], v[112:115], v[100:103], v[36:39]
    ds_read_b64_tr_b16 v[146:147], v162 offset:9216
    buffer_load_dwordx4 v7, s[20:23], s41 offen offset:0 lds
    v_mfma_f32_16x16x32_bf16 v[40:43], v[112:115], v[104:107], v[40:43]
    ds_read_b128 v[128:131], v161 offset:0
    v_mfma_f32_16x16x32_bf16 v[44:47], v[112:115], v[108:111], v[44:47]
    ds_read_b64_tr_b16 v[148:149], v163 offset:8192
    v_mfma_f32_16x16x32_bf16 v[48:51], v[116:119], v[96:99], v[48:51]
    ds_read_b64_tr_b16 v[150:151], v163 offset:9216
    v_mfma_f32_16x16x32_bf16 v[52:55], v[116:119], v[100:103], v[52:55]
    ds_read_b128 v[132:135], v161 offset:2048
    buffer_load_dwordx4 v8, s[20:23], s41 offen offset:1024 lds
    v_mfma_f32_16x16x32_bf16 v[56:59], v[116:119], v[104:107], v[56:59]
    ds_read_b64_tr_b16 v[152:153], v164 offset:8192
    v_mfma_f32_16x16x32_bf16 v[60:63], v[116:119], v[108:111], v[60:63]
    ds_read_b64_tr_b16 v[154:155], v164 offset:9216
    v_mfma_f32_16x16x32_bf16 v[64:67], v[120:123], v[96:99], v[64:67]
    ds_read_b128 v[136:139], v161 offset:4096
    v_mfma_f32_16x16x32_bf16 v[68:71], v[120:123], v[100:103], v[68:71]
    ds_read_b64_tr_b16 v[156:157], v165 offset:8192
    buffer_load_dwordx4 v9, s[20:23], s41 offen offset:2048 lds
    v_mfma_f32_16x16x32_bf16 v[72:75], v[120:123], v[104:107], v[72:75]
    ds_read_b64_tr_b16 v[158:159], v165 offset:9216
    v_mfma_f32_16x16x32_bf16 v[76:79], v[120:123], v[108:111], v[76:79]
    ds_read_b128 v[140:143], v161 offset:6144
    v_mfma_f32_16x16x32_bf16 v[80:83], v[124:127], v[96:99], v[80:83]
    v_mfma_f32_16x16x32_bf16 v[84:87], v[124:127], v[100:103], v[84:87]
    buffer_load_dwordx4 v10, s[20:23], s41 offen offset:3072 lds
    v_mfma_f32_16x16x32_bf16 v[88:91], v[124:127], v[104:107], v[88:91]
    v_mfma_f32_16x16x32_bf16 v[92:95], v[124:127], v[108:111], v[92:95]
    s_waitcnt vmcnt(8) lgkmcnt(0)
    s_barrier
    s_lshl_b32 s40, s39, 7
    s_add_u32 s40, s40, s37
    s_add_u32 m0, s42, 65536
    s_mul_i32 s41, s39, 221184
    v_mfma_f32_16x16x32_bf16 v[32:35], v[144:147], v[128:131], v[32:35]
    ds_read_b64_tr_b16 v[112:113], v24 offset:0
    v_mfma_f32_16x16x32_bf16 v[36:39], v[144:147], v[132:135], v[36:39]
    ds_read_b64_tr_b16 v[114:115], v24 offset:1024
    buffer_load_dwordx4 v3, s[16:19], s40 offen offset:0 lds
    v_mfma_f32_16x16x32_bf16 v[40:43], v[144:147], v[136:139], v[40:43]
    ds_read_b128 v[96:99], v22 offset:0
    v_mfma_f32_16x16x32_bf16 v[44:47], v[144:147], v[140:143], v[44:47]
    ds_read_b64_tr_b16 v[116:117], v25 offset:0
    v_mfma_f32_16x16x32_bf16 v[48:51], v[148:151], v[128:131], v[48:51]
    ds_read_b64_tr_b16 v[118:119], v25 offset:1024
    v_mfma_f32_16x16x32_bf16 v[52:55], v[148:151], v[132:135], v[52:55]
    ds_read_b128 v[100:103], v22 offset:2048
    buffer_load_dwordx4 v4, s[16:19], s40 offen offset:1024 lds
    v_mfma_f32_16x16x32_bf16 v[56:59], v[148:151], v[136:139], v[56:59]
    ds_read_b64_tr_b16 v[120:121], v26 offset:0
    v_mfma_f32_16x16x32_bf16 v[60:63], v[148:151], v[140:143], v[60:63]
    ds_read_b64_tr_b16 v[122:123], v26 offset:1024
    v_mfma_f32_16x16x32_bf16 v[64:67], v[152:155], v[128:131], v[64:67]
    ds_read_b128 v[104:107], v22 offset:4096
    v_mfma_f32_16x16x32_bf16 v[68:71], v[152:155], v[132:135], v[68:71]
    ds_read_b64_tr_b16 v[124:125], v27 offset:0
    buffer_load_dwordx4 v5, s[16:19], s40 offen offset:2048 lds
    v_mfma_f32_16x16x32_bf16 v[72:75], v[152:155], v[136:139], v[72:75]
    ds_read_b64_tr_b16 v[126:127], v27 offset:1024
    v_mfma_f32_16x16x32_bf16 v[76:79], v[152:155], v[140:143], v[76:79]
    ds_read_b128 v[108:111], v22 offset:6144
    v_mfma_f32_16x16x32_bf16 v[80:83], v[156:159], v[128:131], v[80:83]
    v_mfma_f32_16x16x32_bf16 v[84:87], v[156:159], v[132:135], v[84:87]
    buffer_load_dwordx4 v6, s[16:19], s40 offen offset:3072 lds
    v_mfma_f32_16x16x32_bf16 v[88:91], v[156:159], v[136:139], v[88:91]
    v_mfma_f32_16x16x32_bf16 v[92:95], v[156:159], v[140:143], v[92:95]
    s_waitcnt lgkmcnt(0)
    s_add_u32 s41, s41, s38
    s_add_u32 m0, s42, 81920
    s_add_u32 s39, s39, 1
    s_cmp_eq_u32 s39, 10
    s_cselect_b32 s39, 0, s39
    v_mfma_f32_16x16x32_bf16 v[32:35], v[112:115], v[96:99], v[32:35]
    ds_read_b64_tr_b16 v[144:145], v24 offset:8192
    v_mfma_f32_16x16x32_bf16 v[36:39], v[112:115], v[100:103], v[36:39]
    ds_read_b64_tr_b16 v[146:147], v24 offset:9216
    buffer_load_dwordx4 v7, s[20:23], s41 offen offset:0 lds
    v_mfma_f32_16x16x32_bf16 v[40:43], v[112:115], v[104:107], v[40:43]
    ds_read_b128 v[128:131], v23 offset:0
    v_mfma_f32_16x16x32_bf16 v[44:47], v[112:115], v[108:111], v[44:47]
    ds_read_b64_tr_b16 v[148:149], v25 offset:8192
    v_mfma_f32_16x16x32_bf16 v[48:51], v[116:119], v[96:99], v[48:51]
    ds_read_b64_tr_b16 v[150:151], v25 offset:9216
    v_mfma_f32_16x16x32_bf16 v[52:55], v[116:119], v[100:103], v[52:55]
    ds_read_b128 v[132:135], v23 offset:2048
    buffer_load_dwordx4 v8, s[20:23], s41 offen offset:1024 lds
    v_mfma_f32_16x16x32_bf16 v[56:59], v[116:119], v[104:107], v[56:59]
    ds_read_b64_tr_b16 v[152:153], v26 offset:8192
    v_mfma_f32_16x16x32_bf16 v[60:63], v[116:119], v[108:111], v[60:63]
    ds_read_b64_tr_b16 v[154:155], v26 offset:9216
    v_mfma_f32_16x16x32_bf16 v[64:67], v[120:123], v[96:99], v[64:67]
    ds_read_b128 v[136:139], v23 offset:4096
    v_mfma_f32_16x16x32_bf16 v[68:71], v[120:123], v[100:103], v[68:71]
    ds_read_b64_tr_b16 v[156:157], v27 offset:8192
    buffer_load_dwordx4 v9, s[20:23], s41 offen offset:2048 lds
    v_mfma_f32_16x16x32_bf16 v[72:75], v[120:123], v[104:107], v[72:75]
    ds_read_b64_tr_b16 v[158:159], v27 offset:9216
    v_mfma_f32_16x16x32_bf16 v[76:79], v[120:123], v[108:111], v[76:79]
    ds_read_b128 v[140:143], v23 offset:6144
    v_mfma_f32_16x16x32_bf16 v[80:83], v[124:127], v[96:99], v[80:83]
    v_mfma_f32_16x16x32_bf16 v[84:87], v[124:127], v[100:103], v[84:87]
    buffer_load_dwordx4 v10, s[20:23], s41 offen offset:3072 lds
    v_mfma_f32_16x16x32_bf16 v[88:91], v[124:127], v[104:107], v[88:91]
    v_mfma_f32_16x16x32_bf16 v[92:95], v[124:127], v[108:111], v[92:95]
    s_waitcnt vmcnt(8) lgkmcnt(0)
    s_barrier
    s_lshl_b32 s40, s39, 7
    s_add_u32 s40, s40, s37
    s_add_u32 m0, s42, 0
    s_mul_i32 s41, s39, 221184
    v_mfma_f32_16x16x32_bf16 v[32:35], v[144:147], v[128:131], v[32:35]
    ds_read_b64_tr_b16 v[112:113], v24 offset:32768
    v_mfma_f32_16x16x32_bf16 v[36:39], v[144:147], v[132:135], v[36:39]
    ds_read_b64_tr_b16 v[114:115], v24 offset:33792
    buffer_load_dwordx4 v3, s[16:19], s40 offen offset:0 lds
    v_mfma_f32_16x16x32_bf16 v[40:43], v[144:147], v[136:139], v[40:43]
    ds_read_b128 v[96:99], v22 offset:32768
    v_mfma_f32_16x16x32_bf16 v[44:47], v[144:147], v[140:143], v[44:47]
    ds_read_b64_tr_b16 v[116:117], v25 offset:32768
    v_mfma_f32_16x16x32_bf16 v[48:51], v[148:151], v[128:131], v[48:51]
    ds_read_b64_tr_b16 v[118:119], v25 offset:33792
    v_mfma_f32_16x16x32_bf16 v[52:55], v[148:151], v[132:135], v[52:55]
    ds_read_b128 v[100:103], v22 offset:34816
    buffer_load_dwordx4 v4, s[16:19], s40 offen offset:1024 lds
    v_mfma_f32_16x16x32_bf16 v[56:59], v[148:151], v[136:139], v[56:59]
    ds_read_b64_tr_b16 v[120:121], v26 offset:32768
    v_mfma_f32_16x16x32_bf16 v[60:63], v[148:151], v[140:143], v[60:63]
    ds_read_b64_tr_b16 v[122:123], v26 offset:33792
    v_mfma_f32_16x16x32_bf16 v[64:67], v[152:155], v[128:131], v[64:67]
    ds_read_b128 v[104:107], v22 offset:36864
    v_mfma_f32_16x16x32_bf16 v[68:71], v[152:155], v[132:135], v[68:71]
    ds_read_b64_tr_b16 v[124:125], v27 offset:32768
    buffer_load_dwordx4 v5, s[16:19], s40 offen offset:2048 lds
    v_mfma_f32_16x16x32_bf16 v[72:75], v[152:155], v[136:139], v[72:75]
    ds_read_b64_tr_b16 v[126:127], v27 offset:33792
    v_mfma_f32_16x16x32_bf16 v[76:79], v[152:155], v[140:143], v[76:79]
    ds_read_b128 v[108:111], v22 offset:38912
    v_mfma_f32_16x16x32_bf16 v[80:83], v[156:159], v[128:131], v[80:83]
    v_mfma_f32_16x16x32_bf16 v[84:87], v[156:159], v[132:135], v[84:87]
    buffer_load_dwordx4 v6, s[16:19], s40 offen offset:3072 lds
    v_mfma_f32_16x16x32_bf16 v[88:91], v[156:159], v[136:139], v[88:91]
    v_mfma_f32_16x16x32_bf16 v[92:95], v[156:159], v[140:143], v[92:95]
    s_waitcnt lgkmcnt(0)
    s_add_u32 s41, s41, s38
    s_add_u32 m0, s42, 16384
    s_add_u32 s39, s39, 1
    s_cmp_eq_u32 s39, 10
    s_cselect_b32 s39, 0, s39
    v_mfma_f32_16x16x32_bf16 v[32:35], v[112:115], v[96:99], v[32:35]
    ds_read_b64_tr_b16 v[144:145], v24 offset:40960
    v_mfma_f32_16x16x32_bf16 v[36:39], v[112:115], v[100:103], v[36:39]
    ds_read_b64_tr_b16 v[146:147], v24 offset:41984
    buffer_load_dwordx4 v7, s[20:23], s41 offen offset:0 lds
    v_mfma_f32_16x16x32_bf16 v[40:43], v[112:115], v[104:107], v[40:43]
    ds_read_b128 v[128:131], v23 offset:32768
    v_mfma_f32_16x16x32_bf16 v[44:47], v[112:115], v[108:111], v[44:47]
    ds_read_b64_tr_b16 v[148:149], v25 offset:40960
    v_mfma_f32_16x16x32_bf16 v[48:51], v[116:119], v[96:99], v[48:51]
    ds_read_b64_tr_b16 v[150:151], v25 offset:41984
    v_mfma_f32_16x16x32_bf16 v[52:55], v[116:119], v[100:103], v[52:55]
    ds_read_b128 v[132:135], v23 offset:34816
    buffer_load_dwordx4 v8, s[20:23], s41 offen offset:1024 lds
    v_mfma_f32_16x16x32_bf16 v[56:59], v[116:119], v[104:107], v[56:59]
    ds_read_b64_tr_b16 v[152:153], v26 offset:40960
    v_mfma_f32_16x16x32_bf16 v[60:63], v[116:119], v[108:111], v[60:63]
    ds_read_b64_tr_b16 v[154:155], v26 offset:41984
    v_mfma_f32_16x16x32_bf16 v[64:67], v[120:123], v[96:99], v[64:67]
    ds_read_b128 v[136:139], v23 offset:36864
    v_mfma_f32_16x16x32_bf16 v[68:71], v[120:123], v[100:103], v[68:71]
    ds_read_b64_tr_b16 v[156:157], v27 offset:40960
    buffer_load_dwordx4 v9, s[20:23], s41 offen offset:2048 lds
    v_mfma_f32_16x16x32_bf16 v[72:75], v[120:123], v[104:107], v[72:75]
    ds_read_b64_tr_b16 v[158:159], v27 offset:41984
    v_mfma_f32_16x16x32_bf16 v[76:79], v[120:123], v[108:111], v[76:79]
    ds_read_b128 v[140:143], v23 offset:38912
    v_mfma_f32_16x16x32_bf16 v[80:83], v[124:127], v[96:99], v[80:83]
    v_mfma_f32_16x16x32_bf16 v[84:87], v[124:127], v[100:103], v[84:87]
    buffer_load_dwordx4 v10, s[20:23], s41 offen offset:3072 lds
    v_mfma_f32_16x16x32_bf16 v[88:91], v[124:127], v[104:107], v[88:91]
    v_mfma_f32_16x16x32_bf16 v[92:95], v[124:127], v[108:111], v[92:95]
    s_waitcnt vmcnt(8) lgkmcnt(0)
    s_barrier
    s_lshl_b32 s40, s39, 7
    s_add_u32 s40, s40, s37
    s_add_u32 m0, s42, 32768
    s_mul_i32 s41, s39, 221184
    v_mfma_f32_16x16x32_bf16 v[32:35], v[144:147], v[128:131], v[32:35]
    ds_read_b64_tr_b16 v[112:113], v162 offset:0
    v_mfma_f32_16x16x32_bf16 v[36:39], v[144:147], v[132:135], v[36:39]
    ds_read_b64_tr_b16 v[114:115], v162 offset:1024
    buffer_load_dwordx4 v3, s[16:19], s40 offen offset:0 lds
    v_mfma_f32_16x16x32_bf16 v[40:43], v[144:147], v[136:139], v[40:43]
    ds_read_b128 v[96:99], v160 offset:0
    v_mfma_f32_16x16x32_bf16 v[44:47], v[144:147], v[140:143], v[44:47]
    ds_read_b64_tr_b16 v[116:117], v163 offset:0
    v_mfma_f32_16x16x32_bf16 v[48:51], v[148:151], v[128:131], v[48:51]
    ds_read_b64_tr_b16 v[118:119], v163 offset:1024
    v_mfma_f32_16x16x32_bf16 v[52:55], v[148:151], v[132:135], v[52:55]
    ds_read_b128 v[100:103], v160 offset:2048
    buffer_load_dwordx4 v4, s[16:19], s40 offen offset:1024 lds
    v_mfma_f32_16x16x32_bf16 v[56:59], v[148:151], v[136:139], v[56:59]
    ds_read_b64_tr_b16 v[120:121], v164 offset:0
    v_mfma_f32_16x16x32_bf16 v[60:63], v[148:151], v[140:143], v[60:63]
    ds_read_b64_tr_b16 v[122:123], v164 offset:1024
    v_mfma_f32_16x16x32_bf16 v[64:67], v[152:155], v[128:131], v[64:67]
    ds_read_b128 v[104:107], v160 offset:4096
    v_mfma_f32_16x16x32_bf16 v[68:71], v[152:155], v[132:135], v[68:71]
    ds_read_b64_tr_b16 v[124:125], v165 offset:0
    buffer_load_dwordx4 v5, s[16:19], s40 offen offset:2048 lds
    v_mfma_f32_16x16x32_bf16 v[72:75], v[152:155], v[136:139], v[72:75]
    ds_read_b64_tr_b16 v[126:127], v165 offset:1024
    v_mfma_f32_16x16x32_bf16 v[76:79], v[152:155], v[140:143], v[76:79]
    ds_read_b128 v[108:111], v160 offset:6144
    v_mfma_f32_16x16x32_bf16 v[80:83], v[156:159], v[128:131], v[80:83]
    v_mfma_f32_16x16x32_bf16 v[84:87], v[156:159], v[132:135], v[84:87]
    buffer_load_dwordx4 v6, s[16:19], s40 offen offset:3072 lds
    v_mfma_f32_16x16x32_bf16 v[88:91], v[156:159], v[136:139], v[88:91]
    v_mfma_f32_16x16x32_bf16 v[92:95], v[156:159], v[140:143], v[92:95]
    s_waitcnt lgkmcnt(0)
    s_add_u32 s41, s41, s38
    s_add_u32 m0, s42, 49152
    s_add_u32 s39, s39, 1
    s_cmp_eq_u32 s39, 10
    s_cselect_b32 s39, 0, s39
    v_mfma_f32_16x16x32_bf16 v[32:35], v[112:115], v[96:99], v[32:35]
    ds_read_b64_tr_b16 v[144:145], v162 offset:8192
    v_mfma_f32_16x16x32_bf16 v[36:39], v[112:115], v[100:103], v[36:39]
    ds_read_b64_tr_b16 v[146:147], v162 offset:9216
    buffer_load_dwordx4 v7, s[20:23], s41 offen offset:0 lds
    v_mfma_f32_16x16x32_bf16 v[40:43], v[112:115], v[104:107], v[40:43]
    ds_read_b128 v[128:131], v161 offset:0
    v_mfma_f32_16x16x32_bf16 v[44:47], v[112:115], v[108:111], v[44:47]
    ds_read_b64_tr_b16 v[148:149], v163 offset:8192
    v_mfma_f32_16x16x32_bf16 v[48:51], v[116:119], v[96:99], v[48:51]
    ds_read_b64_tr_b16 v[150:151], v163 offset:9216
    v_mfma_f32_16x16x32_bf16 v[52:55], v[116:119], v[100:103], v[52:55]
    ds_read_b128 v[132:135], v161 offset:2048
    buffer_load_dwordx4 v8, s[20:23], s41 offen offset:1024 lds
    v_mfma_f32_16x16x32_bf16 v[56:59], v[116:119], v[104:107], v[56:59]
    ds_read_b64_tr_b16 v[152:153], v164 offset:8192
    v_mfma_f32_16x16x32_bf16 v[60:63], v[116:119], v[108:111], v[60:63]
    ds_read_b64_tr_b16 v[154:155], v164 offset:9216
    v_mfma_f32_16x16x32_bf16 v[64:67], v[120:123], v[96:99], v[64:67]
    ds_read_b128 v[136:139], v161 offset:4096
    v_mfma_f32_16x16x32_bf16 v[68:71], v[120:123], v[100:103], v[68:71]
    ds_read_b64_tr_b16 v[156:157], v165 offset:8192
    buffer_load_dwordx4 v9, s[20:23], s41 offen offset:2048 lds
    v_mfma_f32_16x16x32_bf16 v[72:75], v[120:123], v[104:107], v[72:75]
    ds_read_b64_tr_b16 v[158:159], v165 offset:9216
    v_mfma_f32_16x16x32_bf16 v[76:79], v[120:123], v[108:111], v[76:79]
    ds_read_b128 v[140:143], v161 offset:6144
    v_mfma_f32_16x16x32_bf16 v[80:83], v[124:127], v[96:99], v[80:83]
    v_mfma_f32_16x16x32_bf16 v[84:87], v[124:127], v[100:103], v[84:87]
    buffer_load_dwordx4 v10, s[20:23], s41 offen offset:3072 lds
    v_mfma_f32_16x16x32_bf16 v[88:91], v[124:127], v[104:107], v[88:91]
    v_mfma_f32_16x16x32_bf16 v[92:95], v[124:127], v[108:111], v[92:95]
    s_waitcnt vmcnt(8) lgkmcnt(0)
    s_barrier
    s_lshl_b32 s40, s39, 7
    s_add_u32 s40, s40, s37
    s_add_u32 m0, s42, 65536
    s_mul_i32 s41, s39, 221184
    v_mfma_f32_16x16x32_bf16 v[32:35], v[144:147], v[128:131], v[32:35]
    ds_read_b64_tr_b16 v[112:113], v24 offset:0
    v_mfma_f32_16x16x32_bf16 v[36:39], v[144:147], v[132:135], v[36:39]
    ds_read_b64_tr_b16 v[114:115], v24 offset:1024
    buffer_load_dwordx4 v3, s[16:19], s40 offen offset:0 lds
    v_mfma_f32_16x16x32_bf16 v[40:43], v[144:147], v[136:139], v[40:43]
    ds_read_b128 v[96:99], v22 offset:0
    v_mfma_f32_16x16x32_bf16 v[44:47], v[144:147], v[140:143], v[44:47]
    ds_read_b64_tr_b16 v[116:117], v25 offset:0
    v_mfma_f32_16x16x32_bf16 v[48:51], v[148:151], v[128:131], v[48:51]
    ds_read_b64_tr_b16 v[118:119], v25 offset:1024
    v_mfma_f32_16x16x32_bf16 v[52:55], v[148:151], v[132:135], v[52:55]
    ds_read_b128 v[100:103], v22 offset:2048
    buffer_load_dwordx4 v4, s[16:19], s40 offen offset:1024 lds
    v_mfma_f32_16x16x32_bf16 v[56:59], v[148:151], v[136:139], v[56:59]
    ds_read_b64_tr_b16 v[120:121], v26 offset:0
    v_mfma_f32_16x16x32_bf16 v[60:63], v[148:151], v[140:143], v[60:63]
    ds_read_b64_tr_b16 v[122:123], v26 offset:1024
    v_mfma_f32_16x16x32_bf16 v[64:67], v[152:155], v[128:131], v[64:67]
    ds_read_b128 v[104:107], v22 offset:4096
    v_mfma_f32_16x16x32_bf16 v[68:71], v[152:155], v[132:135], v[68:71]
    ds_read_b64_tr_b16 v[124:125], v27 offset:0
    buffer_load_dwordx4 v5, s[16:19], s40 offen offset:2048 lds
    v_mfma_f32_16x16x32_bf16 v[72:75], v[152:155], v[136:139], v[72:75]
    ds_read_b64_tr_b16 v[126:127], v27 offset:1024
    v_mfma_f32_16x16x32_bf16 v[76:79], v[152:155], v[140:143], v[76:79]
    ds_read_b128 v[108:111], v22 offset:6144
    v_mfma_f32_16x16x32_bf16 v[80:83], v[156:159], v[128:131], v[80:83]
    v_mfma_f32_16x16x32_bf16 v[84:87], v[156:159], v[132:135], v[84:87]
    buffer_load_dwordx4 v6, s[16:19], s40 offen offset:3072 lds
    v_mfma_f32_16x16x32_bf16 v[88:91], v[156:159], v[136:139], v[88:91]
    v_mfma_f32_16x16x32_bf16 v[92:95], v[156:159], v[140:143], v[92:95]
    s_waitcnt lgkmcnt(0)
    s_add_u32 s41, s41, s38
    s_add_u32 m0, s42, 81920
    s_add_u32 s39, s39, 1
    s_cmp_eq_u32 s39, 10
    s_cselect_b32 s39, 0, s39
    v_mfma_f32_16x16x32_bf16 v[32:35], v[112:115], v[96:99], v[32:35]
    ds_read_b64_tr_b16 v[144:145], v24 offset:8192
    v_mfma_f32_16x16x32_bf16 v[36:39], v[112:115], v[100:103], v[36:39]
    ds_read_b64_tr_b16 v[146:147], v24 offset:9216
    buffer_load_dwordx4 v7, s[20:23], s41 offen offset:0 lds
    v_mfma_f32_16x16x32_bf16 v[40:43], v[112:115], v[104:107], v[40:43]
    ds_read_b128 v[128:131], v23 offset:0
    v_mfma_f32_16x16x32_bf16 v[44:47], v[112:115], v[108:111], v[44:47]
    ds_read_b64_tr_b16 v[148:149], v25 offset:8192
    v_mfma_f32_16x16x32_bf16 v[48:51], v[116:119], v[96:99], v[48:51]
    ds_read_b64_tr_b16 v[150:151], v25 offset:9216
    v_mfma_f32_16x16x32_bf16 v[52:55], v[116:119], v[100:103], v[52:55]
    ds_read_b128 v[132:135], v23 offset:2048
    buffer_load_dwordx4 v8, s[20:23], s41 offen offset:1024 lds
    v_mfma_f32_16x16x32_bf16 v[56:59], v[116:119], v[104:107], v[56:59]
    ds_read_b64_tr_b16 v[152:153], v26 offset:8192
    v_mfma_f32_16x16x32_bf16 v[60:63], v[116:119], v[108:111], v[60:63]
    ds_read_b64_tr_b16 v[154:155], v26 offset:9216
    v_mfma_f32_16x16x32_bf16 v[64:67], v[120:123], v[96:99], v[64:67]
    ds_read_b128 v[136:139], v23 offset:4096
    v_mfma_f32_16x16x32_bf16 v[68:71], v[120:123], v[100:103], v[68:71]
    ds_read_b64_tr_b16 v[156:157], v27 offset:8192
    buffer_load_dwordx4 v9, s[20:23], s41 offen offset:2048 lds
    v_mfma_f32_16x16x32_bf16 v[72:75], v[120:123], v[104:107], v[72:75]
    ds_read_b64_tr_b16 v[158:159], v27 offset:9216
    v_mfma_f32_16x16x32_bf16 v[76:79], v[120:123], v[108:111], v[76:79]
    ds_read_b128 v[140:143], v23 offset:6144
    v_mfma_f32_16x16x32_bf16 v[80:83], v[124:127], v[96:99], v[80:83]
    v_mfma_f32_16x16x32_bf16 v[84:87], v[124:127], v[100:103], v[84:87]
    buffer_load_dwordx4 v10, s[20:23], s41 offen offset:3072 lds
    v_mfma_f32_16x16x32_bf16 v[88:91], v[124:127], v[104:107], v[88:91]
    v_mfma_f32_16x16x32_bf16 v[92:95], v[124:127], v[108:111], v[92:95]
    s_waitcnt vmcnt(8) lgkmcnt(0)
    s_barrier
    buffer_load_dword v173, v180, s[32:35], 0 offen sc1
    s_lshl_b32 s40, s39, 7
    s_add_u32 s40, s40, s37
    s_add_u32 m0, s42, 0
    s_mul_i32 s41, s39, 221184
    v_mfma_f32_16x16x32_bf16 v[32:35], v[144:147], v[128:131], v[32:35]
    ds_read_b64_tr_b16 v[112:113], v24 offset:32768
    v_mfma_f32_16x16x32_bf16 v[36:39], v[144:147], v[132:135], v[36:39]
    ds_read_b64_tr_b16 v[114:115], v24 offset:33792
    buffer_load_dwordx4 v3, s[16:19], s40 offen offset:0 lds
    v_mfma_f32_16x16x32_bf16 v[40:43], v[144:147], v[136:139], v[40:43]
    ds_read_b128 v[96:99], v22 offset:32768
    v_mfma_f32_16x16x32_bf16 v[44:47], v[144:147], v[140:143], v[44:47]
    ds_read_b64_tr_b16 v[116:117], v25 offset:32768
    v_mfma_f32_16x16x32_bf16 v[48:51], v[148:151], v[128:131], v[48:51]
    ds_read_b64_tr_b16 v[118:119], v25 offset:33792
    v_mfma_f32_16x16x32_bf16 v[52:55], v[148:151], v[132:135], v[52:55]
    ds_read_b128 v[100:103], v22 offset:34816
    buffer_load_dwordx4 v4, s[16:19], s40 offen offset:1024 lds
    v_mfma_f32_16x16x32_bf16 v[56:59], v[148:151], v[136:139], v[56:59]
    ds_read_b64_tr_b16 v[120:121], v26 offset:32768
    v_mfma_f32_16x16x32_bf16 v[60:63], v[148:151], v[140:143], v[60:63]
    ds_read_b64_tr_b16 v[122:123], v26 offset:33792
    v_mfma_f32_16x16x32_bf16 v[64:67], v[152:155], v[128:131], v[64:67]
    ds_read_b128 v[104:107], v22 offset:36864
    v_mfma_f32_16x16x32_bf16 v[68:71], v[152:155], v[132:135], v[68:71]
    ds_read_b64_tr_b16 v[124:125], v27 offset:32768
    buffer_load_dwordx4 v5, s[16:19], s40 offen offset:2048 lds
    v_mfma_f32_16x16x32_bf16 v[72:75], v[152:155], v[136:139], v[72:75]
    ds_read_b64_tr_b16 v[126:127], v27 offset:33792
    v_mfma_f32_16x16x32_bf16 v[76:79], v[152:155], v[140:143], v[76:79]
    ds_read_b128 v[108:111], v22 offset:38912
    v_mfma_f32_16x16x32_bf16 v[80:83], v[156:159], v[128:131], v[80:83]
    v_mfma_f32_16x16x32_bf16 v[84:87], v[156:159], v[132:135], v[84:87]
    buffer_load_dwordx4 v6, s[16:19], s40 offen offset:3072 lds
    v_mfma_f32_16x16x32_bf16 v[88:91], v[156:159], v[136:139], v[88:91]
    v_mfma_f32_16x16x32_bf16 v[92:95], v[156:159], v[140:143], v[92:95]
    s_waitcnt lgkmcnt(0)
    s_add_u32 s41, s41, s38
    s_add_u32 m0, s42, 16384
    s_add_u32 s39, s39, 1
    s_cmp_eq_u32 s39, 10
    s_cselect_b32 s39, 0, s39
    v_mfma_f32_16x16x32_bf16 v[32:35], v[112:115], v[96:99], v[32:35]
    ds_read_b64_tr_b16 v[144:145], v24 offset:40960
    v_mfma_f32_16x16x32_bf16 v[36:39], v[112:115], v[100:103], v[36:39]
    ds_read_b64_tr_b16 v[146:147], v24 offset:41984
    buffer_load_dwordx4 v7, s[20:23], s41 offen offset:0 lds
    v_mfma_f32_16x16x32_bf16 v[40:43], v[112:115], v[104:107], v[40:43]
    ds_read_b128 v[128:131], v23 offset:32768
    v_mfma_f32_16x16x32_bf16 v[44:47], v[112:115], v[108:111], v[44:47]
    ds_read_b64_tr_b16 v[148:149], v25 offset:40960
    v_mfma_f32_16x16x32_bf16 v[48:51], v[116:119], v[96:99], v[48:51]
    ds_read_b64_tr_b16 v[150:151], v25 offset:41984
    v_mfma_f32_16x16x32_bf16 v[52:55], v[116:119], v[100:103], v[52:55]
    ds_read_b128 v[132:135], v23 offset:34816
    buffer_load_dwordx4 v8, s[20:23], s41 offen offset:1024 lds
    v_mfma_f32_16x16x32_bf16 v[56:59], v[116:119], v[104:107], v[56:59]
    ds_read_b64_tr_b16 v[152:153], v26 offset:40960
    v_mfma_f32_16x16x32_bf16 v[60:63], v[116:119], v[108:111], v[60:63]
    ds_read_b64_tr_b16 v[154:155], v26 offset:41984
    v_mfma_f32_16x16x32_bf16 v[64:67], v[120:123], v[96:99], v[64:67]
    ds_read_b128 v[136:139], v23 offset:36864
    v_mfma_f32_16x16x32_bf16 v[68:71], v[120:123], v[100:103], v[68:71]
    ds_read_b64_tr_b16 v[156:157], v27 offset:40960
    buffer_load_dwordx4 v9, s[20:23], s41 offen offset:2048 lds
    v_mfma_f32_16x16x32_bf16 v[72:75], v[120:123], v[104:107], v[72:75]
    ds_read_b64_tr_b16 v[158:159], v27 offset:41984
    v_mfma_f32_16x16x32_bf16 v[76:79], v[120:123], v[108:111], v[76:79]
    ds_read_b128 v[140:143], v23 offset:38912
    v_mfma_f32_16x16x32_bf16 v[80:83], v[124:127], v[96:99], v[80:83]
    v_mfma_f32_16x16x32_bf16 v[84:87], v[124:127], v[100:103], v[84:87]
    buffer_load_dwordx4 v10, s[20:23], s41 offen offset:3072 lds
    v_mfma_f32_16x16x32_bf16 v[88:91], v[124:127], v[104:107], v[88:91]
    v_mfma_f32_16x16x32_bf16 v[92:95], v[124:127], v[108:111], v[92:95]
    s_waitcnt vmcnt(8) lgkmcnt(0)
    s_barrier
    v_cmp_eq_u32 vcc, 1, v173
    s_nop 0
    s_cmp_eq_u64 vcc, -1
    s_cselect_b32 s49, 0, 1
    v_mfma_f32_16x16x32_bf16 v[32:35], v[144:147], v[128:131], v[32:35]
    ds_read_b64_tr_b16 v[112:113], v162 offset:0
    v_mfma_f32_16x16x32_bf16 v[36:39], v[144:147], v[132:135], v[36:39]
    ds_read_b64_tr_b16 v[114:115], v162 offset:1024
    v_mfma_f32_16x16x32_bf16 v[40:43], v[144:147], v[136:139], v[40:43]
    ds_read_b128 v[96:99], v160 offset:0
    v_mfma_f32_16x16x32_bf16 v[44:47], v[144:147], v[140:143], v[44:47]
    ds_read_b64_tr_b16 v[116:117], v163 offset:0
    v_mfma_f32_16x16x32_bf16 v[48:51], v[148:151], v[128:131], v[48:51]
    ds_read_b64_tr_b16 v[118:119], v163 offset:1024
    v_mfma_f32_16x16x32_bf16 v[52:55], v[148:151], v[132:135], v[52:55]
    ds_read_b128 v[100:103], v160 offset:2048
    v_mfma_f32_16x16x32_bf16 v[56:59], v[148:151], v[136:139], v[56:59]
    ds_read_b64_tr_b16 v[120:121], v164 offset:0
    v_mfma_f32_16x16x32_bf16 v[60:63], v[148:151], v[140:143], v[60:63]
    ds_read_b64_tr_b16 v[122:123], v164 offset:1024
    v_mfma_f32_16x16x32_bf16 v[64:67], v[152:155], v[128:131], v[64:67]
    ds_read_b128 v[104:107], v160 offset:4096
    v_mfma_f32_16x16x32_bf16 v[68:71], v[152:155], v[132:135], v[68:71]
    ds_read_b64_tr_b16 v[124:125], v165 offset:0
    v_mfma_f32_16x16x32_bf16 v[72:75], v[152:155], v[136:139], v[72:75]
    ds_read_b64_tr_b16 v[126:127], v165 offset:1024
    v_mfma_f32_16x16x32_bf16 v[76:79], v[152:155], v[140:143], v[76:79]
    ds_read_b128 v[108:111], v160 offset:6144
    v_mfma_f32_16x16x32_bf16 v[80:83], v[156:159], v[128:131], v[80:83]
    v_mfma_f32_16x16x32_bf16 v[84:87], v[156:159], v[132:135], v[84:87]
    v_mfma_f32_16x16x32_bf16 v[88:91], v[156:159], v[136:139], v[88:91]
    v_mfma_f32_16x16x32_bf16 v[92:95], v[156:159], v[140:143], v[92:95]
    s_waitcnt lgkmcnt(0)
    v_mfma_f32_16x16x32_bf16 v[32:35], v[112:115], v[96:99], v[32:35]
    ds_read_b64_tr_b16 v[144:145], v162 offset:8192
    ds_read_b64_tr_b16 v[146:147], v162 offset:9216
    v_mfma_f32_16x16x32_bf16 v[48:51], v[116:119], v[96:99], v[48:51]
    ds_read_b128 v[128:131], v161 offset:0
    ds_read_b64_tr_b16 v[148:149], v163 offset:8192
    v_mfma_f32_16x16x32_bf16 v[36:39], v[112:115], v[100:103], v[36:39]
    ds_read_b64_tr_b16 v[150:151], v163 offset:9216
    ds_read_b128 v[132:135], v161 offset:2048
    v_mfma_f32_16x16x32_bf16 v[52:55], v[116:119], v[100:103], v[52:55]
    ds_read_b128 v[136:139], v161 offset:4096
    ds_read_b128 v[140:143], v161 offset:6144
    v_mfma_f32_16x16x32_bf16 v[40:43], v[112:115], v[104:107], v[40:43]
    v_mfma_f32_16x16x32_bf16 v[56:59], v[116:119], v[104:107], v[56:59]
    v_mfma_f32_16x16x32_bf16 v[44:47], v[112:115], v[108:111], v[44:47]
    v_mfma_f32_16x16x32_bf16 v[60:63], v[116:119], v[108:111], v[60:63]
    s_waitcnt vmcnt(0) lgkmcnt(0)
    s_barrier
    v_mfma_f32_16x16x32_bf16 v[32:35], v[144:147], v[128:131], v[32:35]
    ds_read_b64_tr_b16 v[112:113], v24 offset:0
    ds_read_b64_tr_b16 v[114:115], v24 offset:1024
    v_mfma_f32_16x16x32_bf16 v[48:51], v[148:151], v[128:131], v[48:51]
    ds_read_b128 v[96:99], v22 offset:0
    ds_read_b64_tr_b16 v[116:117], v25 offset:0
    v_mfma_f32_16x16x32_bf16 v[36:39], v[144:147], v[132:135], v[36:39]
    ds_read_b64_tr_b16 v[118:119], v25 offset:1024
    ds_read_b128 v[100:103], v22 offset:2048
    v_mfma_f32_16x16x32_bf16 v[52:55], v[148:151], v[132:135], v[52:55]
    ds_read_b128 v[104:107], v22 offset:4096
    ds_read_b128 v[108:111], v22 offset:6144
    v_mfma_f32_16x16x32_bf16 v[40:43], v[144:147], v[136:139], v[40:43]
    v_mfma_f32_16x16x32_bf16 v[56:59], v[148:151], v[136:139], v[56:59]
    v_mfma_f32_16x16x32_bf16 v[44:47], v[144:147], v[140:143], v[44:47]
    v_mfma_f32_16x16x32_bf16 v[60:63], v[148:151], v[140:143], v[60:63]
    s_waitcnt lgkmcnt(0)
    v_mfma_f32_16x16x32_bf16 v[32:35], v[112:115], v[96:99], v[32:35]
    ds_read_b64_tr_b16 v[144:145], v24 offset:8192
    ds_read_b64_tr_b16 v[146:147], v24 offset:9216
    v_mfma_f32_16x16x32_bf16 v[48:51], v[116:119], v[96:99], v[48:51]
    ds_read_b128 v[128:131], v23 offset:0
    ds_read_b64_tr_b16 v[148:149], v25 offset:8192
    v_mfma_f32_16x16x32_bf16 v[36:39], v[112:115], v[100:103], v[36:39]
    ds_read_b64_tr_b16 v[150:151], v25 offset:9216
    ds_read_b128 v[132:135], v23 offset:2048
    v_mfma_f32_16x16x32_bf16 v[52:55], v[116:119], v[100:103], v[52:55]
    ds_read_b128 v[136:139], v23 offset:4096
    ds_read_b128 v[140:143], v23 offset:6144
    v_mfma_f32_16x16x32_bf16 v[40:43], v[112:115], v[104:107], v[40:43]
    v_mfma_f32_16x16x32_bf16 v[56:59], v[116:119], v[104:107], v[56:59]
    v_mfma_f32_16x16x32_bf16 v[44:47], v[112:115], v[108:111], v[44:47]
    v_mfma_f32_16x16x32_bf16 v[60:63], v[116:119], v[108:111], v[60:63]
    s_waitcnt lgkmcnt(0)
    v_mfma_f32_16x16x32_bf16 v[32:35], v[144:147], v[128:131], v[32:35]
    ds_read_b128 v[96:99], v160 offset:0
    ds_read_b128 v[100:103], v160 offset:2048
    v_mfma_f32_16x16x32_bf16 v[48:51], v[148:151], v[128:131], v[48:51]
    ds_read_b64_tr_b16 v[120:121], v164 offset:0
    ds_read_b64_tr_b16 v[122:123], v164 offset:1024
    v_mfma_f32_16x16x32_bf16 v[36:39], v[144:147], v[132:135], v[36:39]
    ds_read_b128 v[104:107], v160 offset:4096
    ds_read_b64_tr_b16 v[124:125], v165 offset:0
    v_mfma_f32_16x16x32_bf16 v[52:55], v[148:151], v[132:135], v[52:55]
    ds_read_b64_tr_b16 v[126:127], v165 offset:1024
    ds_read_b128 v[108:111], v160 offset:6144
    v_mfma_f32_16x16x32_bf16 v[40:43], v[144:147], v[136:139], v[40:43]
    v_cvt_pk_bf16_f32 v192, v32, v33
    v_cvt_pk_bf16_f32 v193, v34, v35
    v_cvt_pk_bf16_f32 v194, v48, v49
    v_cvt_pk_bf16_f32 v195, v50, v51
    v_mfma_f32_16x16x32_bf16 v[56:59], v[148:151], v[136:139], v[56:59]
    v_pk_max_i16 v192, v192, 0
    v_pk_max_i16 v193, v193, 0
    v_pk_max_i16 v194, v194, 0
    v_pk_max_i16 v195, v195, 0
    v_mfma_f32_16x16x32_bf16 v[44:47], v[144:147], v[140:143], v[44:47]
    s_add_u32 s51, s43, 0
    buffer_store_dwordx4 v[192:195], v18, s[24:27], s51 offen offset:0 sc1
    v_cvt_pk_bf16_f32 v196, v36, v37
    v_cvt_pk_bf16_f32 v197, v38, v39
    v_mfma_f32_16x16x32_bf16 v[60:63], v[148:151], v[140:143], v[60:63]
    v_cvt_pk_bf16_f32 v198, v52, v53
    v_cvt_pk_bf16_f32 v199, v54, v55
    v_pk_max_i16 v196, v196, 0
    v_pk_max_i16 v197, v197, 0
    s_waitcnt lgkmcnt(0)
    v_mfma_f32_16x16x32_bf16 v[64:67], v[120:123], v[96:99], v[64:67]
    ds_read_b128 v[128:131], v161 offset:0
    ds_read_b128 v[132:135], v161 offset:2048
    v_pk_max_i16 v198, v198, 0
    v_pk_max_i16 v199, v199, 0
    s_add_u32 s51, s43, 55296
    buffer_store_dwordx4 v[196:199], v18, s[24:27], s51 offen offset:0 sc1
    v_mfma_f32_16x16x32_bf16 v[80:83], v[124:127], v[96:99], v[80:83]
    ds_read_b64_tr_b16 v[152:153], v164 offset:8192
    ds_read_b64_tr_b16 v[154:155], v164 offset:9216
    v_cvt_pk_bf16_f32 v200, v40, v41
    v_cvt_pk_bf16_f32 v201, v42, v43
    v_cvt_pk_bf16_f32 v202, v56, v57
    v_cvt_pk_bf16_f32 v203, v58, v59
    v_mfma_f32_16x16x32_bf16 v[68:71], v[120:123], v[100:103], v[68:71]
    ds_read_b128 v[136:139], v161 offset:4096
    ds_read_b64_tr_b16 v[156:157], v165 offset:8192
    v_pk_max_i16 v200, v200, 0
    v_pk_max_i16 v201, v201, 0
    v_pk_max_i16 v202, v202, 0
    v_pk_max_i16 v203, v203, 0
    v_mfma_f32_16x16x32_bf16 v[84:87], v[124:127], v[100:103], v[84:87]
    ds_read_b64_tr_b16 v[158:159], v165 offset:9216
    ds_read_b128 v[140:143], v161 offset:6144
    s_add_u32 s51, s43, 110592
    buffer_store_dwordx4 v[200:203], v18, s[24:27], s51 offen offset:0 sc1
    v_cvt_pk_bf16_f32 v204, v44, v45
    v_cvt_pk_bf16_f32 v205, v46, v47
    v_mfma_f32_16x16x32_bf16 v[72:75], v[120:123], v[104:107], v[72:75]
    v_cvt_pk_bf16_f32 v206, v60, v61
    v_cvt_pk_bf16_f32 v207, v62, v63
    v_pk_max_i16 v204, v204, 0
    v_pk_max_i16 v205, v205, 0
    v_mfma_f32_16x16x32_bf16 v[88:91], v[124:127], v[104:107], v[88:91]
    v_pk_max_i16 v206, v206, 0
    v_pk_max_i16 v207, v207, 0
    s_add_u32 s51, s43, 165888
    buffer_store_dwordx4 v[204:207], v18, s[24:27], s51 offen offset:0 sc1
    v_mfma_f32_16x16x32_bf16 v[76:79], v[120:123], v[108:111], v[76:79]
    v_mfma_f32_16x16x32_bf16 v[92:95], v[124:127], v[108:111], v[92:95]
    s_waitcnt lgkmcnt(0)
    v_mfma_f32_16x16x32_bf16 v[64:67], v[152:155], v[128:131], v[64:67]
    ds_read_b128 v[96:99], v22 offset:0
    ds_read_b128 v[100:103], v22 offset:2048
    v_mfma_f32_16x16x32_bf16 v[80:83], v[156:159], v[128:131], v[80:83]
    ds_read_b64_tr_b16 v[120:121], v26 offset:0
    ds_read_b64_tr_b16 v[122:123], v26 offset:1024
    v_mfma_f32_16x16x32_bf16 v[68:71], v[152:155], v[132:135], v[68:71]
    ds_read_b128 v[104:107], v22 offset:4096
    ds_read_b64_tr_b16 v[124:125], v27 offset:0
    v_mfma_f32_16x16x32_bf16 v[84:87], v[156:159], v[132:135], v[84:87]
    ds_read_b64_tr_b16 v[126:127], v27 offset:1024
    ds_read_b128 v[108:111], v22 offset:6144
    v_mfma_f32_16x16x32_bf16 v[72:75], v[152:155], v[136:139], v[72:75]
    v_mfma_f32_16x16x32_bf16 v[88:91], v[156:159], v[136:139], v[88:91]
    v_mfma_f32_16x16x32_bf16 v[76:79], v[152:155], v[140:143], v[76:79]
    v_mfma_f32_16x16x32_bf16 v[92:95], v[156:159], v[140:143], v[92:95]
    s_waitcnt lgkmcnt(0)
    v_mfma_f32_16x16x32_bf16 v[64:67], v[120:123], v[96:99], v[64:67]
    ds_read_b128 v[128:131], v23 offset:0
    ds_read_b128 v[132:135], v23 offset:2048
    v_mfma_f32_16x16x32_bf16 v[80:83], v[124:127], v[96:99], v[80:83]
    ds_read_b64_tr_b16 v[152:153], v26 offset:8192
    ds_read_b64_tr_b16 v[154:155], v26 offset:9216
    v_mfma_f32_16x16x32_bf16 v[68:71], v[120:123], v[100:103], v[68:71]
    ds_read_b128 v[136:139], v23 offset:4096
    ds_read_b64_tr_b16 v[156:157], v27 offset:8192
    v_mfma_f32_16x16x32_bf16 v[84:87], v[124:127], v[100:103], v[84:87]
    ds_read_b64_tr_b16 v[158:159], v27 offset:9216
    ds_read_b128 v[140:143], v23 offset:6144
    v_mfma_f32_16x16x32_bf16 v[72:75], v[120:123], v[104:107], v[72:75]
    v_mfma_f32_16x16x32_bf16 v[88:91], v[124:127], v[104:107], v[88:91]
    v_mfma_f32_16x16x32_bf16 v[76:79], v[120:123], v[108:111], v[76:79]
    v_mfma_f32_16x16x32_bf16 v[92:95], v[124:127], v[108:111], v[92:95]
    s_waitcnt lgkmcnt(0)
    s_barrier
    v_mfma_f32_16x16x32_bf16 v[64:67], v[152:155], v[128:131], v[64:67]
    v_mfma_f32_16x16x32_bf16 v[80:83], v[156:159], v[128:131], v[80:83]
    v_mfma_f32_16x16x32_bf16 v[68:71], v[152:155], v[132:135], v[68:71]
    v_mfma_f32_16x16x32_bf16 v[84:87], v[156:159], v[132:135], v[84:87]
    v_mfma_f32_16x16x32_bf16 v[72:75], v[152:155], v[136:139], v[72:75]
    v_cvt_pk_bf16_f32 v112, v64, v65
    v_cvt_pk_bf16_f32 v113, v66, v67
    v_cvt_pk_bf16_f32 v114, v80, v81
    v_cvt_pk_bf16_f32 v115, v82, v83
    v_mfma_f32_16x16x32_bf16 v[88:91], v[156:159], v[136:139], v[88:91]
    v_pk_max_i16 v112, v112, 0
    v_pk_max_i16 v113, v113, 0
    v_pk_max_i16 v114, v114, 0
    v_pk_max_i16 v115, v115, 0
    v_mfma_f32_16x16x32_bf16 v[76:79], v[152:155], v[140:143], v[76:79]
    s_add_u32 s51, s43, 0
    buffer_store_dwordx4 v[112:115], v18, s[24:27], s51 offen offset:1024 sc1
    v_cvt_pk_bf16_f32 v116, v68, v69
    v_cvt_pk_bf16_f32 v117, v70, v71
    v_mfma_f32_16x16x32_bf16 v[92:95], v[156:159], v[140:143], v[92:95]
    v_cvt_pk_bf16_f32 v118, v84, v85
    v_cvt_pk_bf16_f32 v119, v86, v87
    v_pk_max_i16 v116, v116, 0
    v_pk_max_i16 v117, v117, 0
    s_nop 7
    v_pk_max_i16 v118, v118, 0
    v_pk_max_i16 v119, v119, 0
    s_add_u32 s51, s43, 55296
    buffer_store_dwordx4 v[116:119], v18, s[24:27], s51 offen offset:1024 sc1
    v_cvt_pk_bf16_f32 v120, v72, v73
    v_cvt_pk_bf16_f32 v121, v74, v75
    v_cvt_pk_bf16_f32 v122, v88, v89
    v_cvt_pk_bf16_f32 v123, v90, v91
    v_pk_max_i16 v120, v120, 0
    v_pk_max_i16 v121, v121, 0
    v_pk_max_i16 v122, v122, 0
    v_pk_max_i16 v123, v123, 0
    s_add_u32 s51, s43, 110592
    buffer_store_dwordx4 v[120:123], v18, s[24:27], s51 offen offset:1024 sc1
    v_cvt_pk_bf16_f32 v124, v76, v77
    v_cvt_pk_bf16_f32 v125, v78, v79
    v_cvt_pk_bf16_f32 v126, v92, v93
    v_cvt_pk_bf16_f32 v127, v94, v95
    v_pk_max_i16 v124, v124, 0
    v_pk_max_i16 v125, v125, 0
    v_pk_max_i16 v126, v126, 0
    v_pk_max_i16 v127, v127, 0
    s_add_u32 s51, s43, 165888
    buffer_store_dwordx4 v[124:127], v18, s[24:27], s51 offen offset:1024 sc1
    s_cmp_lg_u32 s101, 0
    s_cbranch_scc1 Lp2
    s_waitcnt vmcnt(0)
    s_cmp_eq_u32 s49, 0
    s_cbranch_scc1 Lclr_okb
    s_mov_b32 s59, 0x40000
Lspin0:
    buffer_load_dword v173, v180, s[32:35], 0 offen sc1
    s_waitcnt vmcnt(0)
Lspinc0:
    v_cmp_eq_u32 vcc, 1, v173
    s_cmp_eq_u64 vcc, -1
    s_cbranch_scc1 Lspun0
    s_sleep 1
    s_sub_u32 s59, s59, 1
    s_cmp_lg_u32 s59, 0
    s_cbranch_scc1 Lspin0
Lspun0:
Lclr_okb:
    s_mov_b64 exec, 1
    buffer_store_dword v179, v180, s[24:27], s44 offen sc1
    s_mov_b64 exec, -1
    s_endpgm
Lp2:
    s_waitcnt vmcnt(0)
    s_cmp_eq_u32 s49, 0
    s_cbranch_scc1 Lclr_oka
    s_mov_b32 s59, 0x40000
Lspin1:
    buffer_load_dword v173, v180, s[32:35], 0 offen sc1
    s_waitcnt vmcnt(0)
Lspinc1:
    v_cmp_eq_u32 vcc, 1, v173
    s_cmp_eq_u64 vcc, -1
    s_cbranch_scc1 Lspun1
    s_sleep 1
    s_sub_u32 s59, s59, 1
    s_cmp_lg_u32 s59, 0
    s_cbranch_scc1 Lspin1
Lspun1:
Lclr_oka:
    s_mov_b64 exec, 1
    buffer_store_dword v179, v180, s[24:27], s44 offen sc1
    s_mov_b64 exec, -1
    s_add_u32 m0, s100, 0
    s_mul_i32 s51, s47, 163840
    s_add_u32 s51, s51, s45
    s_cmp_eq_u32 s47, 13
    s_cselect_b32 s52, s3, 0
    s_add_u32 s51, s51, s52
    s_add_u32 s47, s47, 1
    s_cmp_eq_u32 s47, 14
    s_cselect_b32 s47, 0, s47
    buffer_load_dwordx4 v181, s[96:99], s51 offen offset:0 lds
    buffer_load_dwordx4 v182, s[96:99], s51 offen offset:1024 lds
    buffer_load_dwordx4 v183, s[96:99], s51 offen offset:2048 lds
    buffer_load_dwordx4 v184, s[96:99], s51 offen offset:3072 lds
    s_add_u32 m0, s100, 4096
    s_mul_i32 s51, s47, 163840
    s_add_u32 s51, s51, s45
    s_cmp_eq_u32 s47, 13
    s_cselect_b32 s52, s3, 0
    s_add_u32 s51, s51, s52
    s_add_u32 s47, s47, 1
    s_cmp_eq_u32 s47, 14
    s_cselect_b32 s47, 0, s47
    buffer_load_dwordx4 v181, s[96:99], s51 offen offset:0 lds
    buffer_load_dwordx4 v182, s[96:99], s51 offen offset:1024 lds
    buffer_load_dwordx4 v183, s[96:99], s51 offen offset:2048 lds
    buffer_load_dwordx4 v184, s[96:99], s51 offen offset:3072 lds
    s_add_u32 m0, s100, 8192
    s_mul_i32 s51, s47, 163840
    s_add_u32 s51, s51, s45
    s_cmp_eq_u32 s47, 13
    s_cselect_b32 s52, s3, 0
    s_add_u32 s51, s51, s52
    s_add_u32 s47, s47, 1
    s_cmp_eq_u32 s47, 14
    s_cselect_b32 s47, 0, s47
    buffer_load_dwordx4 v181, s[96:99], s51 offen offset:0 lds
    buffer_load_dwordx4 v182, s[96:99], s51 offen offset:1024 lds
    buffer_load_dwordx4 v183, s[96:99], s51 offen offset:2048 lds
    buffer_load_dwordx4 v184, s[96:99], s51 offen offset:3072 lds
    s_add_u32 m0, s100, 12288
    s_mul_i32 s51, s47, 163840
    s_add_u32 s51, s51, s45
    s_cmp_eq_u32 s47, 13
    s_cselect_b32 s52, s3, 0
    s_add_u32 s51, s51, s52
    s_add_u32 s47, s47, 1
    s_cmp_eq_u32 s47, 14
    s_cselect_b32 s47, 0, s47
    buffer_load_dwordx4 v181, s[96:99], s51 offen offset:0 lds
    buffer_load_dwordx4 v182, s[96:99], s51 offen offset:1024 lds
    buffer_load_dwordx4 v183, s[96:99], s51 offen offset:2048 lds
    buffer_load_dwordx4 v184, s[96:99], s51 offen offset:3072 lds
    s_add_u32 m0, s53, 0
    s_mul_i32 s51, s47, 163840
    s_add_u32 s51, s51, s45
    s_cmp_eq_u32 s47, 13
    s_cselect_b32 s52, s3, 0
    s_add_u32 s51, s51, s52
    s_add_u32 s47, s47, 1
    s_cmp_eq_u32 s47, 14
    s_cselect_b32 s47, 0, s47
    buffer_load_dwordx4 v181, s[96:99], s51 offen offset:0 lds
    buffer_load_dwordx4 v182, s[96:99], s51 offen offset:1024 lds
    buffer_load_dwordx4 v183, s[96:99], s51 offen offset:2048 lds
    buffer_load_dwordx4 v184, s[96:99], s51 offen offset:3072 lds
    s_add_u32 m0, s53, 4096
    s_mul_i32 s51, s47, 163840
    s_add_u32 s51, s51, s45
    s_cmp_eq_u32 s47, 13
    s_cselect_b32 s52, s3, 0
    s_add_u32 s51, s51, s52
    s_add_u32 s47, s47, 1
    s_cmp_eq_u32 s47, 14
    s_cselect_b32 s47, 0, s47
    buffer_load_dwordx4 v181, s[96:99], s51 offen offset:0 lds
    buffer_load_dwordx4 v182, s[96:99], s51 offen offset:1024 lds
    buffer_load_dwordx4 v183, s[96:99], s51 offen offset:2048 lds
    buffer_load_dwordx4 v184, s[96:99], s51 offen offset:3072 lds
    s_add_u32 m0, s53, 8192
    s_mul_i32 s51, s47, 163840
    s_add_u32 s51, s51, s45
    s_cmp_eq_u32 s47, 13
    s_cselect_b32 s52, s3, 0
    s_add_u32 s51, s51, s52
    s_add_u32 s47, s47, 1
    s_cmp_eq_u32 s47, 14
    s_cselect_b32 s47, 0, s47
    buffer_load_dwordx4 v181, s[96:99], s51 offen offset:0 lds
    buffer_load_dwordx4 v182, s[96:99], s51 offen offset:1024 lds
    buffer_load_dwordx4 v183, s[96:99], s51 offen offset:2048 lds
    buffer_load_dwordx4 v184, s[96:99], s51 offen offset:3072 lds
    s_add_u32 m0, s53, 12288
    s_mul_i32 s51, s47, 163840
    s_add_u32 s51, s51, s45
    s_cmp_eq_u32 s47, 13
    s_cselect_b32 s52, s3, 0
    s_add_u32 s51, s51, s52
    s_add_u32 s47, s47, 1
    s_cmp_eq_u32 s47, 14
    s_cselect_b32 s47, 0, s47
    buffer_load_dwordx4 v181, s[96:99], s51 offen offset:0 lds
    buffer_load_dwordx4 v182, s[96:99], s51 offen offset:1024 lds
    buffer_load_dwordx4 v183, s[96:99], s51 offen offset:2048 lds
    buffer_load_dwordx4 v184, s[96:99], s51 offen offset:3072 lds
    s_add_u32 m0, s53, 16384
    s_mul_i32 s51, s47, 163840
    s_add_u32 s51, s51, s45
    s_cmp_eq_u32 s47, 13
    s_cselect_b32 s52, s3, 0
    s_add_u32 s51, s51, s52
    s_add_u32 s47, s47, 1
    s_cmp_eq_u32 s47, 14
    s_cselect_b32 s47, 0, s47
    buffer_load_dwordx4 v181, s[96:99], s51 offen offset:0 lds
    buffer_load_dwordx4 v182, s[96:99], s51 offen offset:1024 lds
    buffer_load_dwordx4 v183, s[96:99], s51 offen offset:2048 lds
    buffer_load_dwordx4 v184, s[96:99], s51 offen offset:3072 lds
    s_add_u32 m0, s53, 20480
    s_mul_i32 s51, s47, 163840
    s_add_u32 s51, s51, s45
    s_cmp_eq_u32 s47, 13
    s_cselect_b32 s52, s3, 0
    s_add_u32 s51, s51, s52
    s_add_u32 s47, s47, 1
    s_cmp_eq_u32 s47, 14
    s_cselect_b32 s47, 0, s47
    buffer_load_dwordx4 v181, s[96:99], s51 offen offset:0 lds
    buffer_load_dwordx4 v182, s[96:99], s51 offen offset:1024 lds
    buffer_load_dwordx4 v183, s[96:99], s51 offen offset:2048 lds
    buffer_load_dwordx4 v184, s[96:99], s51 offen offset:3072 lds
    s_waitcnt vmcnt(36)
    ds_read_b64_tr_b16 a[0:1], v185 offset:0
    ds_read_b64_tr_b16 a[2:3], v185 offset:2048
    ds_read_b64_tr_b16 a[4:5], v186 offset:0
    ds_read_b64_tr_b16 a[6:7], v186 offset:2048
    ds_read_b64_tr_b16 a[8:9], v187 offset:0
    ds_read_b64_tr_b16 a[10:11], v187 offset:2048
    ds_read_b64_tr_b16 a[12:13], v188 offset:0
    ds_read_b64_tr_b16 a[14:15], v188 offset:2048
    s_waitcnt vmcnt(32)
    ds_read_b64_tr_b16 a[16:17], v185 offset:4096
    ds_read_b64_tr_b16 a[18:19], v185 offset:6144
    ds_read_b64_tr_b16 a[20:21], v186 offset:4096
    ds_read_b64_tr_b16 a[22:23], v186 offset:6144
    ds_read_b64_tr_b16 a[24:25], v187 offset:4096
    ds_read_b64_tr_b16 a[26:27], v187 offset:6144
    ds_read_b64_tr_b16 a[28:29], v188 offset:4096
    ds_read_b64_tr_b16 a[30:31], v188 offset:6144
    s_waitcnt vmcnt(28)
    ds_read_b64_tr_b16 a[32:33], v185 offset:8192
    ds_read_b64_tr_b16 a[34:35], v185 offset:10240
    ds_read_b64_tr_b16 a[36:37], v186 offset:8192
    ds_read_b64_tr_b16 a[38:39], v186 offset:10240
    ds_read_b64_tr_b16 a[40:41], v187 offset:8192
    ds_read_b64_tr_b16 a[42:43], v187 offset:10240
    ds_read_b64_tr_b16 a[44:45], v188 offset:8192
    ds_read_b64_tr_b16 a[46:47], v188 offset:10240
    s_waitcnt vmcnt(24)
    ds_read_b64_tr_b16 a[48:49], v185 offset:12288
    ds_read_b64_tr_b16 a[50:51], v185 offset:14336
    ds_read_b64_tr_b16 a[52:53], v186 offset:12288
    ds_read_b64_tr_b16 a[54:55], v186 offset:14336
    ds_read_b64_tr_b16 a[56:57], v187 offset:12288
    ds_read_b64_tr_b16 a[58:59], v187 offset:14336
    ds_read_b64_tr_b16 a[60:61], v188 offset:12288
    ds_read_b64_tr_b16 a[62:63], v188 offset:14336
    s_waitcnt lgkmcnt(15)
    s_add_u32 m0, s100, 0
    s_mul_i32 s51, s47, 163840
    s_add_u32 s51, s51, s45
    s_cmp_eq_u32 s47, 13
    s_cselect_b32 s52, s3, 0
    s_add_u32 s51, s51, s52
    s_add_u32 s47, s47, 1
    s_cmp_eq_u32 s47, 14
    s_cselect_b32 s47, 0, s47
    buffer_load_dwordx4 v181, s[96:99], s51 offen offset:0 lds
    buffer_load_dwordx4 v182, s[96:99], s51 offen offset:1024 lds
    buffer_load_dwordx4 v183, s[96:99], s51 offen offset:2048 lds
    buffer_load_dwordx4 v184, s[96:99], s51 offen offset:3072 lds
    s_waitcnt lgkmcnt(15)
    s_add_u32 m0, s100, 4096
    s_mul_i32 s51, s47, 163840
    s_add_u32 s51, s51, s45
    s_cmp_eq_u32 s47, 13
    s_cselect_b32 s52, s3, 0
    s_add_u32 s51, s51, s52
    s_add_u32 s47, s47, 1
    s_cmp_eq_u32 s47, 14
    s_cselect_b32 s47, 0, s47
    buffer_load_dwordx4 v181, s[96:99], s51 offen offset:0 lds
    buffer_load_dwordx4 v182, s[96:99], s51 offen offset:1024 lds
    buffer_load_dwordx4 v183, s[96:99], s51 offen offset:2048 lds
    buffer_load_dwordx4 v184, s[96:99], s51 offen offset:3072 lds
    s_waitcnt lgkmcnt(8)
    s_add_u32 m0, s100, 8192
    s_mul_i32 s51, s47, 163840
    s_add_u32 s51, s51, s45
    s_cmp_eq_u32 s47, 13
    s_cselect_b32 s52, s3, 0
    s_add_u32 s51, s51, s52
    s_add_u32 s47, s47, 1
    s_cmp_eq_u32 s47, 14
    s_cselect_b32 s47, 0, s47
    buffer_load_dwordx4 v181, s[96:99], s51 offen offset:0 lds
    buffer_load_dwordx4 v182, s[96:99], s51 offen offset:1024 lds
    buffer_load_dwordx4 v183, s[96:99], s51 offen offset:2048 lds
    buffer_load_dwordx4 v184, s[96:99], s51 offen offset:3072 lds
    s_waitcnt lgkmcnt(0)
    s_add_u32 m0, s100, 12288
    s_mul_i32 s51, s47, 163840
    s_add_u32 s51, s51, s45
    s_cmp_eq_u32 s47, 13
    s_cselect_b32 s52, s3, 0
    s_add_u32 s51, s51, s52
    s_add_u32 s47, s47, 1
    s_cmp_eq_u32 s47, 14
    s_cselect_b32 s47, 0, s47
    buffer_load_dwordx4 v181, s[96:99], s51 offen offset:0 lds
    buffer_load_dwordx4 v182, s[96:99], s51 offen offset:1024 lds
    buffer_load_dwordx4 v183, s[96:99], s51 offen offset:2048 lds
    buffer_load_dwordx4 v184, s[96:99], s51 offen offset:3072 lds
    buffer_load_dwordx4 v[28:31], v172, s[24:27], s54 offen sc1
    s_waitcnt vmcnt(37)
    ds_read_b64_tr_b16 a[64:65], v252 offset:0
    ds_read_b64_tr_b16 a[66:67], v252 offset:2048
    ds_read_b64_tr_b16 a[68:69], v253 offset:0
    ds_read_b64_tr_b16 a[70:71], v253 offset:2048
    ds_read_b64_tr_b16 a[72:73], v254 offset:0
    ds_read_b64_tr_b16 a[74:75], v254 offset:2048
    ds_read_b64_tr_b16 a[76:77], v255 offset:0
    ds_read_b64_tr_b16 a[78:79], v255 offset:2048
    s_waitcnt vmcnt(33)
    ds_read_b64_tr_b16 a[80:81], v252 offset:4096
    ds_read_b64_tr_b16 a[82:83], v252 offset:6144
    ds_read_b64_tr_b16 a[84:85], v253 offset:4096
    ds_read_b64_tr_b16 a[86:87], v253 offset:6144
    ds_read_b64_tr_b16 a[88:89], v254 offset:4096
    ds_read_b64_tr_b16 a[90:91], v254 offset:6144
    ds_read_b64_tr_b16 a[92:93], v255 offset:4096
    ds_read_b64_tr_b16 a[94:95], v255 offset:6144
    s_waitcnt vmcnt(29)
    ds_read_b64_tr_b16 a[96:97], v252 offset:8192
    ds_read_b64_tr_b16 a[98:99], v252 offset:10240
    ds_read_b64_tr_b16 a[100:101], v253 offset:8192
    ds_read_b64_tr_b16 a[102:103], v253 offset:10240
    ds_read_b64_tr_b16 a[104:105], v254 offset:8192
    ds_read_b64_tr_b16 a[106:107], v254 offset:10240
    ds_read_b64_tr_b16 a[108:109], v255 offset:8192
    ds_read_b64_tr_b16 a[110:111], v255 offset:10240
    s_waitcnt vmcnt(25)
    ds_read_b64_tr_b16 a[112:113], v252 offset:12288
    ds_read_b64_tr_b16 a[114:115], v252 offset:14336
    ds_read_b64_tr_b16 a[116:117], v253 offset:12288
    ds_read_b64_tr_b16 a[118:119], v253 offset:14336
    ds_read_b64_tr_b16 a[120:121], v254 offset:12288
    ds_read_b64_tr_b16 a[122:123], v254 offset:14336
    ds_read_b64_tr_b16 a[124:125], v255 offset:12288
    ds_read_b64_tr_b16 a[126:127], v255 offset:14336
    s_waitcnt vmcnt(21)
    ds_read_b64_tr_b16 a[128:129], v252 offset:16384
    ds_read_b64_tr_b16 a[130:131], v252 offset:18432
    ds_read_b64_tr_b16 a[132:133], v253 offset:16384
    ds_read_b64_tr_b16 a[134:135], v253 offset:18432
    ds_read_b64_tr_b16 a[136:137], v254 offset:16384
    ds_read_b64_tr_b16 a[138:139], v254 offset:18432
    ds_read_b64_tr_b16 a[140:141], v255 offset:16384
    ds_read_b64_tr_b16 a[142:143], v255 offset:18432
    s_waitcnt vmcnt(17)
    ds_read_b64_tr_b16 a[144:145], v252 offset:20480
    ds_read_b64_tr_b16 a[146:147], v252 offset:22528
    ds_read_b64_tr_b16 a[148:149], v253 offset:20480
    ds_read_b64_tr_b16 a[150:151], v253 offset:22528
    ds_read_b64_tr_b16 a[152:153], v254 offset:20480
    ds_read_b64_tr_b16 a[154:155], v254 offset:22528
    ds_read_b64_tr_b16 a[156:157], v255 offset:20480
    ds_read_b64_tr_b16 a[158:159], v255 offset:22528
    s_waitcnt vmcnt(13)
    ds_read_b64_tr_b16 a[160:161], v185 offset:0
    ds_read_b64_tr_b16 a[162:163], v185 offset:2048
    ds_read_b64_tr_b16 a[164:165], v186 offset:0
    ds_read_b64_tr_b16 a[166:167], v186 offset:2048
    ds_read_b64_tr_b16 a[168:169], v187 offset:0
    ds_read_b64_tr_b16 a[170:171], v187 offset:2048
    ds_read_b64_tr_b16 a[172:173], v188 offset:0
    ds_read_b64_tr_b16 a[174:175], v188 offset:2048
    s_waitcnt vmcnt(9)
    ds_read_b64_tr_b16 a[176:177], v185 offset:4096
    ds_read_b64_tr_b16 a[178:179], v185 offset:6144
    ds_read_b64_tr_b16 a[180:181], v186 offset:4096
    ds_read_b64_tr_b16 a[182:183], v186 offset:6144
    ds_read_b64_tr_b16 a[184:185], v187 offset:4096
    ds_read_b64_tr_b16 a[186:187], v187 offset:6144
    ds_read_b64_tr_b16 a[188:189], v188 offset:4096
    ds_read_b64_tr_b16 a[190:191], v188 offset:6144
    s_waitcnt vmcnt(5)
    ds_read_b64_tr_b16 a[192:193], v185 offset:8192
    ds_read_b64_tr_b16 a[194:195], v185 offset:10240
    ds_read_b64_tr_b16 a[196:197], v186 offset:8192
    ds_read_b64_tr_b16 a[198:199], v186 offset:10240
    ds_read_b64_tr_b16 a[200:201], v187 offset:8192
    ds_read_b64_tr_b16 a[202:203], v187 offset:10240
    ds_read_b64_tr_b16 a[204:205], v188 offset:8192
    ds_read_b64_tr_b16 a[206:207], v188 offset:10240
    s_waitcnt vmcnt(1)
    ds_read_b64_tr_b16 a[208:209], v185 offset:12288
    ds_read_b64_tr_b16 a[210:211], v185 offset:14336
    ds_read_b64_tr_b16 a[212:213], v186 offset:12288
    ds_read_b64_tr_b16 a[214:215], v186 offset:14336
    ds_read_b64_tr_b16 a[216:217], v187 offset:12288
    ds_read_b64_tr_b16 a[218:219], v187 offset:14336
    ds_read_b64_tr_b16 a[220:221], v188 offset:12288
    ds_read_b64_tr_b16 a[222:223], v188 offset:14336
    s_cmp_lg_u32 s36, 0
    s_cbranch_scc1 Lgo_5
    s_waitcnt vmcnt(0)
    s_mov_b32 s59, 0x40000
    s_branch Lspinc2
Lspin2:
    buffer_load_dwordx4 v[28:31], v172, s[24:27], 0 offen sc1
    s_waitcnt vmcnt(0)
Lspinc2:
    v_and_b32 v173, v28, v29
    v_and_b32 v173, v173, v30
    v_and_b32 v173, v173, v31
    v_cmp_eq_u32 vcc, 1, v173
    s_cmp_eq_u64 vcc, -1
    s_cbranch_scc1 Lspun2
    s_sleep 1
    s_sub_u32 s59, s59, 1
    s_cmp_lg_u32 s59, 0
    s_cbranch_scc1 Lspin2
Lspun2:
Lgo_5:
    s_barrier
    s_mov_b32 s49, s47
    s_mov_b32 s47, s48
    s_mul_i32 s51, s47, 4096
    s_add_u32 s51, s51, s46
    s_cmp_eq_u32 s47, 13
    s_cselect_b32 s52, s50, 0
    s_add_u32 s51, s51, s52
    s_add_u32 s47, s47, 1
    s_cmp_eq_u32 s47, 14
    s_cselect_b32 s47, 0, s47
    buffer_load_dwordx4 v[112:115], v166, s[24:27], s51 offen sc1
    buffer_load_dwordx4 v[116:119], v167, s[24:27], s51 offen sc1
    buffer_load_dwordx4 v[120:123], v168, s[24:27], s51 offen sc1
    buffer_load_dwordx4 v[124:127], v169, s[24:27], s51 offen sc1
    buffer_load_dwordx4 v[128:131], v170, s[24:27], s51 offen sc1
    s_mul_i32 s51, s47, 4096
    s_add_u32 s51, s51, s46
    s_cmp_eq_u32 s47, 13
    s_cselect_b32 s52, s50, 0
    s_add_u32 s51, s51, s52
    s_add_u32 s47, s47, 1
    s_cmp_eq_u32 s47, 14
    s_cselect_b32 s47, 0, s47
    buffer_load_dwordx4 v[132:135], v166, s[24:27], s51 offen sc1
    buffer_load_dwordx4 v[136:139], v167, s[24:27], s51 offen sc1
    buffer_load_dwordx4 v[140:143], v168, s[24:27], s51 offen sc1
    buffer_load_dwordx4 v[144:147], v169, s[24:27], s51 offen sc1
    buffer_load_dwordx4 v[148:151], v170, s[24:27], s51 offen sc1
    s_mul_i32 s51, s47, 4096
    s_add_u32 s51, s51, s46
    s_cmp_eq_u32 s47, 13
    s_cselect_b32 s52, s50, 0
    s_add_u32 s51, s51, s52
    s_add_u32 s47, s47, 1
    s_cmp_eq_u32 s47, 14
    s_cselect_b32 s47, 0, s47
    buffer_load_dwordx4 v[192:195], v166, s[24:27], s51 offen sc1
    buffer_load_dwordx4 v[196:199], v167, s[24:27], s51 offen sc1
    buffer_load_dwordx4 v[200:203], v168, s[24:27], s51 offen sc1
    buffer_load_dwordx4 v[204:207], v169, s[24:27], s51 offen sc1
    buffer_load_dwordx4 v[208:211], v170, s[24:27], s51 offen sc1
    s_waitcnt lgkmcnt(0)
    s_waitcnt vmcnt(10)
    v_mfma_f32_16x16x32_bf16 v[32:35], a[0:3], v[112:115], 0
    s_mul_i32 s51, s47, 4096
    s_add_u32 s51, s51, s46
    v_mfma_f32_16x16x32_bf16 v[36:39], a[0:3], v[116:119], 0
    s_cmp_eq_u32 s47, 13
    s_cselect_b32 s52, s50, 0
    v_mfma_f32_16x16x32_bf16 v[40:43], a[0:3], v[120:123], 0
    s_add_u32 s51, s51, s52
    s_add_u32 s47, s47, 1
    v_mfma_f32_16x16x32_bf16 v[44:47], a[0:3], v[124:127], 0
    s_cmp_eq_u32 s47, 14
    s_cselect_b32 s47, 0, s47
    v_mfma_f32_16x16x32_bf16 v[48:51], a[0:3], v[128:131], 0
    buffer_load_dwordx4 v[212:215], v166, s[24:27], s51 offen sc1
    v_mfma_f32_16x16x32_bf16 v[52:55], a[4:7], v[112:115], 0
    v_mfma_f32_16x16x32_bf16 v[56:59], a[4:7], v[116:119], 0
    v_mfma_f32_16x16x32_bf16 v[60:63], a[4:7], v[120:123], 0
    buffer_load_dwordx4 v[216:219], v167, s[24:27], s51 offen sc1
    v_mfma_f32_16x16x32_bf16 v[64:67], a[4:7], v[124:127], 0
    v_mfma_f32_16x16x32_bf16 v[68:71], a[4:7], v[128:131], 0
    v_mfma_f32_16x16x32_bf16 v[72:75], a[8:11], v[112:115], 0
    buffer_load_dwordx4 v[220:223], v168, s[24:27], s51 offen sc1
    v_mfma_f32_16x16x32_bf16 v[76:79], a[8:11], v[116:119], 0
    v_mfma_f32_16x16x32_bf16 v[80:83], a[8:11], v[120:123], 0
    v_mfma_f32_16x16x32_bf16 v[84:87], a[8:11], v[124:127], 0
    buffer_load_dwordx4 v[224:227], v169, s[24:27], s51 offen sc1
    v_mfma_f32_16x16x32_bf16 v[88:91], a[8:11], v[128:131], 0
    v_mfma_f32_16x16x32_bf16 v[92:95], a[12:15], v[112:115], 0
    v_mfma_f32_16x16x32_bf16 v[96:99], a[12:15], v[116:119], 0
    buffer_load_dwordx4 v[228:231], v170, s[24:27], s51 offen sc1
    v_mfma_f32_16x16x32_bf16 v[100:103], a[12:15], v[120:123], 0
    v_mfma_f32_16x16x32_bf16 v[104:107], a[12:15], v[124:127], 0
    v_mfma_f32_16x16x32_bf16 v[108:111], a[12:15], v[128:131], 0
    s_waitcnt vmcnt(10)
    v_mfma_f32_16x16x32_bf16 v[32:35], a[16:19], v[132:135], v[32:35]
    s_mul_i32 s51, s47, 4096
    s_add_u32 s51, s51, s46
    v_mfma_f32_16x16x32_bf16 v[36:39], a[16:19], v[136:139], v[36:39]
    s_cmp_eq_u32 s47, 13
    s_cselect_b32 s52, s50, 0
    v_mfma_f32_16x16x32_bf16 v[40:43], a[16:19], v[140:143], v[40:43]
    s_add_u32 s51, s51, s52
    s_add_u32 s47, s47, 1
    v_mfma_f32_16x16x32_bf16 v[44:47], a[16:19], v[144:147], v[44:47]
    s_cmp_eq_u32 s47, 14
    s_cselect_b32 s47, 0, s47
    v_mfma_f32_16x16x32_bf16 v[48:51], a[16:19], v[148:151], v[48:51]
    buffer_load_dwordx4 v[112:115], v166, s[24:27], s51 offen sc1
    v_mfma_f32_16x16x32_bf16 v[52:55], a[20:23], v[132:135], v[52:55]
    v_mfma_f32_16x16x32_bf16 v[56:59], a[20:23], v[136:139], v[56:59]
    v_mfma_f32_16x16x32_bf16 v[60:63], a[20:23], v[140:143], v[60:63]
    buffer_load_dwordx4 v[116:119], v167, s[24:27], s51 offen sc1
    v_mfma_f32_16x16x32_bf16 v[64:67], a[20:23], v[144:147], v[64:67]
    v_mfma_f32_16x16x32_bf16 v[68:71], a[20:23], v[148:151], v[68:71]
    v_mfma_f32_16x16x32_bf16 v[72:75], a[24:27], v[132:135], v[72:75]
    buffer_load_dwordx4 v[120:123], v168, s[24:27], s51 offen sc1
    v_mfma_f32_16x16x32_bf16 v[76:79], a[24:27], v[136:139], v[76:79]
    v_mfma_f32_16x16x32_bf16 v[80:83], a[24:27], v[140:143], v[80:83]
    v_mfma_f32_16x16x32_bf16 v[84:87], a[24:27], v[144:147], v[84:87]
    buffer_load_dwordx4 v[124:127], v169, s[24:27], s51 offen sc1
    v_mfma_f32_16x16x32_bf16 v[88:91], a[24:27], v[148:151], v[88:91]
    v_mfma_f32_16x16x32_bf16 v[92:95], a[28:31], v[132:135], v[92:95]
    v_mfma_f32_16x16x32_bf16 v[96:99], a[28:31], v[136:139], v[96:99]
    buffer_load_dwordx4 v[128:131], v170, s[24:27], s51 offen sc1
    v_mfma_f32_16x16x32_bf16 v[100:103], a[28:31], v[140:143], v[100:103]
    v_mfma_f32_16x16x32_bf16 v[104:107], a[28:31], v[144:147], v[104:107]
    v_mfma_f32_16x16x32_bf16 v[108:111], a[28:31], v[148:151], v[108:111]
    s_waitcnt vmcnt(10)
    v_mfma_f32_16x16x32_bf16 v[32:35], a[32:35], v[192:195], v[32:35]
    s_mul_i32 s51, s47, 4096
    s_add_u32 s51, s51, s46
    v_mfma_f32_16x16x32_bf16 v[36:39], a[32:35], v[196:199], v[36:39]
    s_cmp_eq_u32 s47, 13
    s_cselect_b32 s52, s50, 0
    v_mfma_f32_16x16x32_bf16 v[40:43], a[32:35], v[200:203], v[40:43]
    s_add_u32 s51, s51, s52
    s_add_u32 s47, s47, 1
    v_mfma_f32_16x16x32_bf16 v[44:47], a[32:35], v[204:207], v[44:47]
    s_cmp_eq_u32 s47, 14
    s_cselect_b32 s47, 0, s47
    v_mfma_f32_16x16x32_bf16 v[48:51], a[32:35], v[208:211], v[48:51]
    buffer_load_dwordx4 v[132:135], v166, s[24:27], s51 offen sc1
    v_mfma_f32_16x16x32_bf16 v[52:55], a[36:39], v[192:195], v[52:55]
    v_mfma_f32_16x16x32_bf16 v[56:59], a[36:39], v[196:199], v[56:59]
    v_mfma_f32_16x16x32_bf16 v[60:63], a[36:39], v[200:203], v[60:63]
    buffer_load_dwordx4 v[136:139], v167, s[24:27], s51 offen sc1
    v_mfma_f32_16x16x32_bf16 v[64:67], a[36:39], v[204:207], v[64:67]
    v_mfma_f32_16x16x32_bf16 v[68:71], a[36:39], v[208:211], v[68:71]
    v_mfma_f32_16x16x32_bf16 v[72:75], a[40:43], v[192:195], v[72:75]
    buffer_load_dwordx4 v[140:143], v168, s[24:27], s51 offen sc1
    v_mfma_f32_16x16x32_bf16 v[76:79], a[40:43], v[196:199], v[76:79]
    v_mfma_f32_16x16x32_bf16 v[80:83], a[40:43], v[200:203], v[80:83]
    v_mfma_f32_16x16x32_bf16 v[84:87], a[40:43], v[204:207], v[84:87]
    buffer_load_dwordx4 v[144:147], v169, s[24:27], s51 offen sc1
    v_mfma_f32_16x16x32_bf16 v[88:91], a[40:43], v[208:211], v[88:91]
    v_mfma_f32_16x16x32_bf16 v[92:95], a[44:47], v[192:195], v[92:95]
    v_mfma_f32_16x16x32_bf16 v[96:99], a[44:47], v[196:199], v[96:99]
    buffer_load_dwordx4 v[148:151], v170, s[24:27], s51 offen sc1
    v_mfma_f32_16x16x32_bf16 v[100:103], a[44:47], v[200:203], v[100:103]
    v_mfma_f32_16x16x32_bf16 v[104:107], a[44:47], v[204:207], v[104:107]
    v_mfma_f32_16x16x32_bf16 v[108:111], a[44:47], v[208:211], v[108:111]
    s_waitcnt vmcnt(10)
    v_mfma_f32_16x16x32_bf16 v[32:35], a[48:51], v[212:215], v[32:35]
    s_mul_i32 s51, s47, 4096
    s_add_u32 s51, s51, s46
    v_mfma_f32_16x16x32_bf16 v[36:39], a[48:51], v[216:219], v[36:39]
    s_cmp_eq_u32 s47, 13
    s_cselect_b32 s52, s50, 0
    v_mfma_f32_16x16x32_bf16 v[40:43], a[48:51], v[220:223], v[40:43]
    s_add_u32 s51, s51, s52
    s_add_u32 s47, s47, 1
    v_mfma_f32_16x16x32_bf16 v[44:47], a[48:51], v[224:227], v[44:47]
    s_cmp_eq_u32 s47, 14
    s_cselect_b32 s47, 0, s47
    v_mfma_f32_16x16x32_bf16 v[48:51], a[48:51], v[228:231], v[48:51]
    buffer_load_dwordx4 v[192:195], v166, s[24:27], s51 offen sc1
    v_mfma_f32_16x16x32_bf16 v[52:55], a[52:55], v[212:215], v[52:55]
    v_mfma_f32_16x16x32_bf16 v[56:59], a[52:55], v[216:219], v[56:59]
    v_mfma_f32_16x16x32_bf16 v[60:63], a[52:55], v[220:223], v[60:63]
    buffer_load_dwordx4 v[196:199], v167, s[24:27], s51 offen sc1
    v_mfma_f32_16x16x32_bf16 v[64:67], a[52:55], v[224:227], v[64:67]
    v_mfma_f32_16x16x32_bf16 v[68:71], a[52:55], v[228:231], v[68:71]
    v_mfma_f32_16x16x32_bf16 v[72:75], a[56:59], v[212:215], v[72:75]
    buffer_load_dwordx4 v[200:203], v168, s[24:27], s51 offen sc1
    v_mfma_f32_16x16x32_bf16 v[76:79], a[56:59], v[216:219], v[76:79]
    v_mfma_f32_16x16x32_bf16 v[80:83], a[56:59], v[220:223], v[80:83]
    v_mfma_f32_16x16x32_bf16 v[84:87], a[56:59], v[224:227], v[84:87]
    buffer_load_dwordx4 v[204:207], v169, s[24:27], s51 offen sc1
    v_mfma_f32_16x16x32_bf16 v[88:91], a[56:59], v[228:231], v[88:91]
    v_mfma_f32_16x16x32_bf16 v[92:95], a[60:63], v[212:215], v[92:95]
    v_mfma_f32_16x16x32_bf16 v[96:99], a[60:63], v[216:219], v[96:99]
    buffer_load_dwordx4 v[208:211], v170, s[24:27], s51 offen sc1
    v_mfma_f32_16x16x32_bf16 v[100:103], a[60:63], v[220:223], v[100:103]
    v_mfma_f32_16x16x32_bf16 v[104:107], a[60:63], v[224:227], v[104:107]
    v_mfma_f32_16x16x32_bf16 v[108:111], a[60:63], v[228:231], v[108:111]
    s_waitcnt vmcnt(10)
    v_mfma_f32_16x16x32_bf16 v[32:35], a[64:67], v[112:115], v[32:35]
    s_mul_i32 s51, s47, 4096
    s_add_u32 s51, s51, s46
    v_mfma_f32_16x16x32_bf16 v[36:39], a[64:67], v[116:119], v[36:39]
    s_cmp_eq_u32 s47, 13
    s_cselect_b32 s52, s50, 0
    v_mfma_f32_16x16x32_bf16 v[40:43], a[64:67], v[120:123], v[40:43]
    s_add_u32 s51, s51, s52
    s_add_u32 s47, s47, 1
    v_mfma_f32_16x16x32_bf16 v[44:47], a[64:67], v[124:127], v[44:47]
    s_cmp_eq_u32 s47, 14
    s_cselect_b32 s47, 0, s47
    v_mfma_f32_16x16x32_bf16 v[48:51], a[64:67], v[128:131], v[48:51]
    buffer_load_dwordx4 v[212:215], v166, s[24:27], s51 offen sc1
    v_mfma_f32_16x16x32_bf16 v[52:55], a[68:71], v[112:115], v[52:55]
    v_mfma_f32_16x16x32_bf16 v[56:59], a[68:71], v[116:119], v[56:59]
    v_mfma_f32_16x16x32_bf16 v[60:63], a[68:71], v[120:123], v[60:63]
    buffer_load_dwordx4 v[216:219], v167, s[24:27], s51 offen sc1
    v_mfma_f32_16x16x32_bf16 v[64:67], a[68:71], v[124:127], v[64:67]
    v_mfma_f32_16x16x32_bf16 v[68:71], a[68:71], v[128:131], v[68:71]
    v_mfma_f32_16x16x32_bf16 v[72:75], a[72:75], v[112:115], v[72:75]
    buffer_load_dwordx4 v[220:223], v168, s[24:27], s51 offen sc1
    v_mfma_f32_16x16x32_bf16 v[76:79], a[72:75], v[116:119], v[76:79]
    v_mfma_f32_16x16x32_bf16 v[80:83], a[72:75], v[120:123], v[80:83]
    v_mfma_f32_16x16x32_bf16 v[84:87], a[72:75], v[124:127], v[84:87]
    buffer_load_dwordx4 v[224:227], v169, s[24:27], s51 offen sc1
    v_mfma_f32_16x16x32_bf16 v[88:91], a[72:75], v[128:131], v[88:91]
    v_mfma_f32_16x16x32_bf16 v[92:95], a[76:79], v[112:115], v[92:95]
    v_mfma_f32_16x16x32_bf16 v[96:99], a[76:79], v[116:119], v[96:99]
    buffer_load_dwordx4 v[228:231], v170, s[24:27], s51 offen sc1
    v_mfma_f32_16x16x32_bf16 v[100:103], a[76:79], v[120:123], v[100:103]
    v_mfma_f32_16x16x32_bf16 v[104:107], a[76:79], v[124:127], v[104:107]
    v_mfma_f32_16x16x32_bf16 v[108:111], a[76:79], v[128:131], v[108:111]
    s_waitcnt vmcnt(10)
    v_mfma_f32_16x16x32_bf16 v[32:35], a[80:83], v[132:135], v[32:35]
    s_mul_i32 s51, s47, 4096
    s_add_u32 s51, s51, s46
    v_mfma_f32_16x16x32_bf16 v[36:39], a[80:83], v[136:139], v[36:39]
    s_cmp_eq_u32 s47, 13
    s_cselect_b32 s52, s50, 0
    v_mfma_f32_16x16x32_bf16 v[40:43], a[80:83], v[140:143], v[40:43]
    s_add_u32 s51, s51, s52
    s_add_u32 s47, s47, 1
    v_mfma_f32_16x16x32_bf16 v[44:47], a[80:83], v[144:147], v[44:47]
    s_cmp_eq_u32 s47, 14
    s_cselect_b32 s47, 0, s47
    v_mfma_f32_16x16x32_bf16 v[48:51], a[80:83], v[148:151], v[48:51]
    buffer_load_dwordx4 v[112:115], v166, s[24:27], s51 offen sc1
    v_mfma_f32_16x16x32_bf16 v[52:55], a[84:87], v[132:135], v[52:55]
    v_mfma_f32_16x16x32_bf16 v[56:59], a[84:87], v[136:139], v[56:59]
    v_mfma_f32_16x16x32_bf16 v[60:63], a[84:87], v[140:143], v[60:63]
    buffer_load_dwordx4 v[116:119], v167, s[24:27], s51 offen sc1
    v_mfma_f32_16x16x32_bf16 v[64:67], a[84:87], v[144:147], v[64:67]
    v_mfma_f32_16x16x32_bf16 v[68:71], a[84:87], v[148:151], v[68:71]
    v_mfma_f32_16x16x32_bf16 v[72:75], a[88:91], v[132:135], v[72:75]
    buffer_load_dwordx4 v[120:123], v168, s[24:27], s51 offen sc1
    v_mfma_f32_16x16x32_bf16 v[76:79], a[88:91], v[136:139], v[76:79]
    v_mfma_f32_16x16x32_bf16 v[80:83], a[88:91], v[140:143], v[80:83]
    v_mfma_f32_16x16x32_bf16 v[84:87], a[88:91], v[144:147], v[84:87]
    buffer_load_dwordx4 v[124:127], v169, s[24:27], s51 offen sc1
    v_mfma_f32_16x16x32_bf16 v[88:91], a[88:91], v[148:151], v[88:91]
    v_mfma_f32_16x16x32_bf16 v[92:95], a[92:95], v[132:135], v[92:95]
    v_mfma_f32_16x16x32_bf16 v[96:99], a[92:95], v[136:139], v[96:99]
    buffer_load_dwordx4 v[128:131], v170, s[24:27], s51 offen sc1
    v_mfma_f32_16x16x32_bf16 v[100:103], a[92:95], v[140:143], v[100:103]
    v_mfma_f32_16x16x32_bf16 v[104:107], a[92:95], v[144:147], v[104:107]
    v_mfma_f32_16x16x32_bf16 v[108:111], a[92:95], v[148:151], v[108:111]
    s_waitcnt vmcnt(10)
    v_mfma_f32_16x16x32_bf16 v[32:35], a[96:99], v[192:195], v[32:35]
    s_mul_i32 s51, s47, 4096
    s_add_u32 s51, s51, s46
    v_mfma_f32_16x16x32_bf16 v[36:39], a[96:99], v[196:199], v[36:39]
    s_cmp_eq_u32 s47, 13
    s_cselect_b32 s52, s50, 0
    v_mfma_f32_16x16x32_bf16 v[40:43], a[96:99], v[200:203], v[40:43]
    s_add_u32 s51, s51, s52
    s_add_u32 s47, s47, 1
    v_mfma_f32_16x16x32_bf16 v[44:47], a[96:99], v[204:207], v[44:47]
    s_cmp_eq_u32 s47, 14
    s_cselect_b32 s47, 0, s47
    v_mfma_f32_16x16x32_bf16 v[48:51], a[96:99], v[208:211], v[48:51]
    buffer_load_dwordx4 v[132:135], v166, s[24:27], s51 offen sc1
    v_mfma_f32_16x16x32_bf16 v[52:55], a[100:103], v[192:195], v[52:55]
    v_mfma_f32_16x16x32_bf16 v[56:59], a[100:103], v[196:199], v[56:59]
    v_mfma_f32_16x16x32_bf16 v[60:63], a[100:103], v[200:203], v[60:63]
    buffer_load_dwordx4 v[136:139], v167, s[24:27], s51 offen sc1
    v_mfma_f32_16x16x32_bf16 v[64:67], a[100:103], v[204:207], v[64:67]
    v_mfma_f32_16x16x32_bf16 v[68:71], a[100:103], v[208:211], v[68:71]
    v_mfma_f32_16x16x32_bf16 v[72:75], a[104:107], v[192:195], v[72:75]
    buffer_load_dwordx4 v[140:143], v168, s[24:27], s51 offen sc1
    v_mfma_f32_16x16x32_bf16 v[76:79], a[104:107], v[196:199], v[76:79]
    v_mfma_f32_16x16x32_bf16 v[80:83], a[104:107], v[200:203], v[80:83]
    v_mfma_f32_16x16x32_bf16 v[84:87], a[104:107], v[204:207], v[84:87]
    buffer_load_dwordx4 v[144:147], v169, s[24:27], s51 offen sc1
    v_mfma_f32_16x16x32_bf16 v[88:91], a[104:107], v[208:211], v[88:91]
    v_mfma_f32_16x16x32_bf16 v[92:95], a[108:111], v[192:195], v[92:95]
    v_mfma_f32_16x16x32_bf16 v[96:99], a[108:111], v[196:199], v[96:99]
    buffer_load_dwordx4 v[148:151], v170, s[24:27], s51 offen sc1
    v_mfma_f32_16x16x32_bf16 v[100:103], a[108:111], v[200:203], v[100:103]
    v_mfma_f32_16x16x32_bf16 v[104:107], a[108:111], v[204:207], v[104:107]
    v_mfma_f32_16x16x32_bf16 v[108:111], a[108:111], v[208:211], v[108:111]
    s_waitcnt vmcnt(10)
    v_mfma_f32_16x16x32_bf16 v[32:35], a[112:115], v[212:215], v[32:35]
    s_mul_i32 s51, s47, 4096
    s_add_u32 s51, s51, s46
    v_mfma_f32_16x16x32_bf16 v[36:39], a[112:115], v[216:219], v[36:39]
    s_cmp_eq_u32 s47, 13
    s_cselect_b32 s52, s50, 0
    v_mfma_f32_16x16x32_bf16 v[40:43], a[112:115], v[220:223], v[40:43]
    s_add_u32 s51, s51, s52
    s_add_u32 s47, s47, 1
    v_mfma_f32_16x16x32_bf16 v[44:47], a[112:115], v[224:227], v[44:47]
    s_cmp_eq_u32 s47, 14
    s_cselect_b32 s47, 0, s47
    v_mfma_f32_16x16x32_bf16 v[48:51], a[112:115], v[228:231], v[48:51]
    buffer_load_dwordx4 v[192:195], v166, s[24:27], s51 offen sc1
    v_mfma_f32_16x16x32_bf16 v[52:55], a[116:119], v[212:215], v[52:55]
    v_mfma_f32_16x16x32_bf16 v[56:59], a[116:119], v[216:219], v[56:59]
    v_mfma_f32_16x16x32_bf16 v[60:63], a[116:119], v[220:223], v[60:63]
    buffer_load_dwordx4 v[196:199], v167, s[24:27], s51 offen sc1
    v_mfma_f32_16x16x32_bf16 v[64:67], a[116:119], v[224:227], v[64:67]
    v_mfma_f32_16x16x32_bf16 v[68:71], a[116:119], v[228:231], v[68:71]
    v_mfma_f32_16x16x32_bf16 v[72:75], a[120:123], v[212:215], v[72:75]
    buffer_load_dwordx4 v[200:203], v168, s[24:27], s51 offen sc1
    v_mfma_f32_16x16x32_bf16 v[76:79], a[120:123], v[216:219], v[76:79]
    v_mfma_f32_16x16x32_bf16 v[80:83], a[120:123], v[220:223], v[80:83]
    v_mfma_f32_16x16x32_bf16 v[84:87], a[120:123], v[224:227], v[84:87]
    buffer_load_dwordx4 v[204:207], v169, s[24:27], s51 offen sc1
    v_mfma_f32_16x16x32_bf16 v[88:91], a[120:123], v[228:231], v[88:91]
    v_mfma_f32_16x16x32_bf16 v[92:95], a[124:127], v[212:215], v[92:95]
    v_mfma_f32_16x16x32_bf16 v[96:99], a[124:127], v[216:219], v[96:99]
    buffer_load_dwordx4 v[208:211], v170, s[24:27], s51 offen sc1
    v_mfma_f32_16x16x32_bf16 v[100:103], a[124:127], v[220:223], v[100:103]
    v_mfma_f32_16x16x32_bf16 v[104:107], a[124:127], v[224:227], v[104:107]
    v_mfma_f32_16x16x32_bf16 v[108:111], a[124:127], v[228:231], v[108:111]
    s_waitcnt vmcnt(10)
    v_mfma_f32_16x16x32_bf16 v[32:35], a[128:131], v[112:115], v[32:35]
    s_mul_i32 s51, s47, 4096
    s_add_u32 s51, s51, s46
    v_mfma_f32_16x16x32_bf16 v[36:39], a[128:131], v[116:119], v[36:39]
    s_cmp_eq_u32 s47, 13
    s_cselect_b32 s52, s50, 0
    v_mfma_f32_16x16x32_bf16 v[40:43], a[128:131], v[120:123], v[40:43]
    s_add_u32 s51, s51, s52
    s_add_u32 s47, s47, 1
    v_mfma_f32_16x16x32_bf16 v[44:47], a[128:131], v[124:127], v[44:47]
    s_cmp_eq_u32 s47, 14
    s_cselect_b32 s47, 0, s47
    v_mfma_f32_16x16x32_bf16 v[48:51], a[128:131], v[128:131], v[48:51]
    buffer_load_dwordx4 v[212:215], v166, s[24:27], s51 offen sc1
    v_mfma_f32_16x16x32_bf16 v[52:55], a[132:135], v[112:115], v[52:55]
    v_mfma_f32_16x16x32_bf16 v[56:59], a[132:135], v[116:119], v[56:59]
    v_mfma_f32_16x16x32_bf16 v[60:63], a[132:135], v[120:123], v[60:63]
    buffer_load_dwordx4 v[216:219], v167, s[24:27], s51 offen sc1
    v_mfma_f32_16x16x32_bf16 v[64:67], a[132:135], v[124:127], v[64:67]
    v_mfma_f32_16x16x32_bf16 v[68:71], a[132:135], v[128:131], v[68:71]
    v_mfma_f32_16x16x32_bf16 v[72:75], a[136:139], v[112:115], v[72:75]
    buffer_load_dwordx4 v[220:223], v168, s[24:27], s51 offen sc1
    v_mfma_f32_16x16x32_bf16 v[76:79], a[136:139], v[116:119], v[76:79]
    v_mfma_f32_16x16x32_bf16 v[80:83], a[136:139], v[120:123], v[80:83]
    v_mfma_f32_16x16x32_bf16 v[84:87], a[136:139], v[124:127], v[84:87]
    buffer_load_dwordx4 v[224:227], v169, s[24:27], s51 offen sc1
    v_mfma_f32_16x16x32_bf16 v[88:91], a[136:139], v[128:131], v[88:91]
    v_mfma_f32_16x16x32_bf16 v[92:95], a[140:143], v[112:115], v[92:95]
    v_mfma_f32_16x16x32_bf16 v[96:99], a[140:143], v[116:119], v[96:99]
    buffer_load_dwordx4 v[228:231], v170, s[24:27], s51 offen sc1
    v_mfma_f32_16x16x32_bf16 v[100:103], a[140:143], v[120:123], v[100:103]
    v_mfma_f32_16x16x32_bf16 v[104:107], a[140:143], v[124:127], v[104:107]
    v_mfma_f32_16x16x32_bf16 v[108:111], a[140:143], v[128:131], v[108:111]
    s_waitcnt vmcnt(10)
    v_mfma_f32_16x16x32_bf16 v[32:35], a[144:147], v[132:135], v[32:35]
    s_mul_i32 s51, s47, 4096
    s_add_u32 s51, s51, s46
    v_mfma_f32_16x16x32_bf16 v[36:39], a[144:147], v[136:139], v[36:39]
    s_cmp_eq_u32 s47, 13
    s_cselect_b32 s52, s50, 0
    v_mfma_f32_16x16x32_bf16 v[40:43], a[144:147], v[140:143], v[40:43]
    s_add_u32 s51, s51, s52
    s_add_u32 s47, s47, 1
    v_mfma_f32_16x16x32_bf16 v[44:47], a[144:147], v[144:147], v[44:47]
    s_cmp_eq_u32 s47, 14
    s_cselect_b32 s47, 0, s47
    v_mfma_f32_16x16x32_bf16 v[48:51], a[144:147], v[148:151], v[48:51]
    buffer_load_dwordx4 v[112:115], v166, s[24:27], s51 offen sc1
    v_mfma_f32_16x16x32_bf16 v[52:55], a[148:151], v[132:135], v[52:55]
    v_mfma_f32_16x16x32_bf16 v[56:59], a[148:151], v[136:139], v[56:59]
    v_mfma_f32_16x16x32_bf16 v[60:63], a[148:151], v[140:143], v[60:63]
    buffer_load_dwordx4 v[116:119], v167, s[24:27], s51 offen sc1
    v_mfma_f32_16x16x32_bf16 v[64:67], a[148:151], v[144:147], v[64:67]
    v_mfma_f32_16x16x32_bf16 v[68:71], a[148:151], v[148:151], v[68:71]
    v_mfma_f32_16x16x32_bf16 v[72:75], a[152:155], v[132:135], v[72:75]
    buffer_load_dwordx4 v[120:123], v168, s[24:27], s51 offen sc1
    v_mfma_f32_16x16x32_bf16 v[76:79], a[152:155], v[136:139], v[76:79]
    v_mfma_f32_16x16x32_bf16 v[80:83], a[152:155], v[140:143], v[80:83]
    v_mfma_f32_16x16x32_bf16 v[84:87], a[152:155], v[144:147], v[84:87]
    buffer_load_dwordx4 v[124:127], v169, s[24:27], s51 offen sc1
    v_mfma_f32_16x16x32_bf16 v[88:91], a[152:155], v[148:151], v[88:91]
    v_mfma_f32_16x16x32_bf16 v[92:95], a[156:159], v[132:135], v[92:95]
    v_mfma_f32_16x16x32_bf16 v[96:99], a[156:159], v[136:139], v[96:99]
    buffer_load_dwordx4 v[128:131], v170, s[24:27], s51 offen sc1
    v_mfma_f32_16x16x32_bf16 v[100:103], a[156:159], v[140:143], v[100:103]
    v_mfma_f32_16x16x32_bf16 v[104:107], a[156:159], v[144:147], v[104:107]
    v_mfma_f32_16x16x32_bf16 v[108:111], a[156:159], v[148:151], v[108:111]
    s_waitcnt vmcnt(10)
    v_mfma_f32_16x16x32_bf16 v[32:35], a[160:163], v[192:195], v[32:35]
    s_mul_i32 s51, s47, 4096
    s_add_u32 s51, s51, s46
    v_mfma_f32_16x16x32_bf16 v[36:39], a[160:163], v[196:199], v[36:39]
    s_cmp_eq_u32 s47, 13
    s_cselect_b32 s52, s50, 0
    v_mfma_f32_16x16x32_bf16 v[40:43], a[160:163], v[200:203], v[40:43]
    s_add_u32 s51, s51, s52
    s_add_u32 s47, s47, 1
    v_mfma_f32_16x16x32_bf16 v[44:47], a[160:163], v[204:207], v[44:47]
    s_cmp_eq_u32 s47, 14
    s_cselect_b32 s47, 0, s47
    v_mfma_f32_16x16x32_bf16 v[48:51], a[160:163], v[208:211], v[48:51]
    buffer_load_dwordx4 v[132:135], v166, s[24:27], s51 offen sc1
    v_mfma_f32_16x16x32_bf16 v[52:55], a[164:167], v[192:195], v[52:55]
    v_mfma_f32_16x16x32_bf16 v[56:59], a[164:167], v[196:199], v[56:59]
    v_mfma_f32_16x16x32_bf16 v[60:63], a[164:167], v[200:203], v[60:63]
    buffer_load_dwordx4 v[136:139], v167, s[24:27], s51 offen sc1
    v_mfma_f32_16x16x32_bf16 v[64:67], a[164:167], v[204:207], v[64:67]
    v_mfma_f32_16x16x32_bf16 v[68:71], a[164:167], v[208:211], v[68:71]
    v_mfma_f32_16x16x32_bf16 v[72:75], a[168:171], v[192:195], v[72:75]
    buffer_load_dwordx4 v[140:143], v168, s[24:27], s51 offen sc1
    v_mfma_f32_16x16x32_bf16 v[76:79], a[168:171], v[196:199], v[76:79]
    v_mfma_f32_16x16x32_bf16 v[80:83], a[168:171], v[200:203], v[80:83]
    v_mfma_f32_16x16x32_bf16 v[84:87], a[168:171], v[204:207], v[84:87]
    buffer_load_dwordx4 v[144:147], v169, s[24:27], s51 offen sc1
    v_mfma_f32_16x16x32_bf16 v[88:91], a[168:171], v[208:211], v[88:91]
    v_mfma_f32_16x16x32_bf16 v[92:95], a[172:175], v[192:195], v[92:95]
    v_mfma_f32_16x16x32_bf16 v[96:99], a[172:175], v[196:199], v[96:99]
    buffer_load_dwordx4 v[148:151], v170, s[24:27], s51 offen sc1
    v_mfma_f32_16x16x32_bf16 v[100:103], a[172:175], v[200:203], v[100:103]
    v_mfma_f32_16x16x32_bf16 v[104:107], a[172:175], v[204:207], v[104:107]
    v_mfma_f32_16x16x32_bf16 v[108:111], a[172:175], v[208:211], v[108:111]
    s_waitcnt vmcnt(10)
    v_mfma_f32_16x16x32_bf16 v[32:35], a[176:179], v[212:215], v[32:35]
    v_mfma_f32_16x16x32_bf16 v[36:39], a[176:179], v[216:219], v[36:39]
    v_mfma_f32_16x16x32_bf16 v[40:43], a[176:179], v[220:223], v[40:43]
    v_mfma_f32_16x16x32_bf16 v[44:47], a[176:179], v[224:227], v[44:47]
    v_mfma_f32_16x16x32_bf16 v[48:51], a[176:179], v[228:231], v[48:51]
    v_mfma_f32_16x16x32_bf16 v[52:55], a[180:183], v[212:215], v[52:55]
    v_mfma_f32_16x16x32_bf16 v[56:59], a[180:183], v[216:219], v[56:59]
    v_mfma_f32_16x16x32_bf16 v[60:63], a[180:183], v[220:223], v[60:63]
    v_mfma_f32_16x16x32_bf16 v[64:67], a[180:183], v[224:227], v[64:67]
    v_mfma_f32_16x16x32_bf16 v[68:71], a[180:183], v[228:231], v[68:71]
    v_mfma_f32_16x16x32_bf16 v[72:75], a[184:187], v[212:215], v[72:75]
    v_mfma_f32_16x16x32_bf16 v[76:79], a[184:187], v[216:219], v[76:79]
    v_mfma_f32_16x16x32_bf16 v[80:83], a[184:187], v[220:223], v[80:83]
    v_mfma_f32_16x16x32_bf16 v[84:87], a[184:187], v[224:227], v[84:87]
    v_mfma_f32_16x16x32_bf16 v[88:91], a[184:187], v[228:231], v[88:91]
    v_mfma_f32_16x16x32_bf16 v[92:95], a[188:191], v[212:215], v[92:95]
    v_mfma_f32_16x16x32_bf16 v[96:99], a[188:191], v[216:219], v[96:99]
    v_mfma_f32_16x16x32_bf16 v[100:103], a[188:191], v[220:223], v[100:103]
    v_mfma_f32_16x16x32_bf16 v[104:107], a[188:191], v[224:227], v[104:107]
    v_mfma_f32_16x16x32_bf16 v[108:111], a[188:191], v[228:231], v[108:111]
    s_waitcnt vmcnt(5)
    v_mfma_f32_16x16x32_bf16 v[32:35], a[192:195], v[112:115], v[32:35]
    v_mfma_f32_16x16x32_bf16 v[36:39], a[192:195], v[116:119], v[36:39]
    v_mfma_f32_16x16x32_bf16 v[40:43], a[192:195], v[120:123], v[40:43]
    v_mfma_f32_16x16x32_bf16 v[44:47], a[192:195], v[124:127], v[44:47]
    v_mfma_f32_16x16x32_bf16 v[48:51], a[192:195], v[128:131], v[48:51]
    v_mfma_f32_16x16x32_bf16 v[52:55], a[196:199], v[112:115], v[52:55]
    v_mfma_f32_16x16x32_bf16 v[56:59], a[196:199], v[116:119], v[56:59]
    v_mfma_f32_16x16x32_bf16 v[60:63], a[196:199], v[120:123], v[60:63]
    v_mfma_f32_16x16x32_bf16 v[64:67], a[196:199], v[124:127], v[64:67]
    v_mfma_f32_16x16x32_bf16 v[68:71], a[196:199], v[128:131], v[68:71]
    v_mfma_f32_16x16x32_bf16 v[72:75], a[200:203], v[112:115], v[72:75]
    v_mfma_f32_16x16x32_bf16 v[76:79], a[200:203], v[116:119], v[76:79]
    v_mfma_f32_16x16x32_bf16 v[80:83], a[200:203], v[120:123], v[80:83]
    v_mfma_f32_16x16x32_bf16 v[84:87], a[200:203], v[124:127], v[84:87]
    v_mfma_f32_16x16x32_bf16 v[88:91], a[200:203], v[128:131], v[88:91]
    v_mfma_f32_16x16x32_bf16 v[92:95], a[204:207], v[112:115], v[92:95]
    v_mfma_f32_16x16x32_bf16 v[96:99], a[204:207], v[116:119], v[96:99]
    v_mfma_f32_16x16x32_bf16 v[100:103], a[204:207], v[120:123], v[100:103]
    v_mfma_f32_16x16x32_bf16 v[104:107], a[204:207], v[124:127], v[104:107]
    v_mfma_f32_16x16x32_bf16 v[108:111], a[204:207], v[128:131], v[108:111]
    s_waitcnt vmcnt(0)
    v_mfma_f32_16x16x32_bf16 v[52:55], a[212:215], v[132:135], v[52:55]
    v_mfma_f32_16x16x32_bf16 v[56:59], a[212:215], v[136:139], v[56:59]
    v_mfma_f32_16x16x32_bf16 v[60:63], a[212:215], v[140:143], v[60:63]
    v_mfma_f32_16x16x32_bf16 v[64:67], a[212:215], v[144:147], v[64:67]
    v_mfma_f32_16x16x32_bf16 v[68:71], a[212:215], v[148:151], v[68:71]
    v_mfma_f32_16x16x32_bf16 v[72:75], a[216:219], v[132:135], v[72:75]
    ds_write_b128 v174, v[52:55] offset:0
    v_mfma_f32_16x16x32_bf16 v[76:79], a[216:219], v[136:139], v[76:79]
    ds_write_b128 v174, v[56:59] offset:1024
    v_mfma_f32_16x16x32_bf16 v[80:83], a[216:219], v[140:143], v[80:83]
    ds_write_b128 v174, v[60:63] offset:2048
    v_mfma_f32_16x16x32_bf16 v[84:87], a[216:219], v[144:147], v[84:87]
    ds_write_b128 v174, v[64:67] offset:3072
    v_mfma_f32_16x16x32_bf16 v[88:91], a[216:219], v[148:151], v[88:91]
    ds_write_b128 v174, v[68:71] offset:4096
    v_mfma_f32_16x16x32_bf16 v[92:95], a[220:223], v[132:135], v[92:95]
    ds_write_b128 v175, v[72:75] offset:0
    v_mfma_f32_16x16x32_bf16 v[96:99], a[220:223], v[136:139], v[96:99]
    ds_write_b128 v175, v[76:79] offset:1024
    v_mfma_f32_16x16x32_bf16 v[100:103], a[220:223], v[140:143], v[100:103]
    ds_write_b128 v175, v[80:83] offset:2048
    v_mfma_f32_16x16x32_bf16 v[104:107], a[220:223], v[144:147], v[104:107]
    ds_write_b128 v175, v[84:87] offset:3072
    v_mfma_f32_16x16x32_bf16 v[108:111], a[220:223], v[148:151], v[108:111]
    ds_write_b128 v175, v[88:91] offset:4096
    v_mfma_f32_16x16x32_bf16 v[32:35], a[208:211], v[132:135], v[32:35]
    ds_write_b128 v176, v[92:95] offset:0
    v_mfma_f32_16x16x32_bf16 v[36:39], a[208:211], v[136:139], v[36:39]
    ds_write_b128 v176, v[96:99] offset:1024
    v_mfma_f32_16x16x32_bf16 v[40:43], a[208:211], v[140:143], v[40:43]
    ds_write_b128 v176, v[100:103] offset:2048
    v_mfma_f32_16x16x32_bf16 v[44:47], a[208:211], v[144:147], v[44:47]
    ds_write_b128 v176, v[104:107] offset:3072
    v_mfma_f32_16x16x32_bf16 v[48:51], a[208:211], v[148:151], v[48:51]
    ds_write_b128 v176, v[108:111] offset:4096
    s_waitcnt lgkmcnt(0)
    s_barrier
    ds_read_b128 v[128:131], v177 offset:0
    ds_read_b128 v[132:135], v177 offset:5120
    ds_read_b128 v[136:139], v177 offset:10240
    ds_read_b128 v[140:143], v177 offset:1024
    ds_read_b128 v[144:147], v177 offset:6144
    ds_read_b128 v[148:151], v177 offset:11264
    ds_read_b128 v[152:155], v177 offset:2048
    ds_read_b128 v[156:159], v177 offset:7168
    ds_read_b128 v[192:195], v177 offset:12288
    ds_read_b128 v[196:199], v177 offset:3072
    ds_read_b128 v[200:203], v177 offset:8192
    ds_read_b128 v[204:207], v177 offset:13312
    ds_read_b128 v[208:211], v177 offset:4096
    ds_read_b128 v[212:215], v177 offset:9216
    ds_read_b128 v[216:219], v177 offset:14336
    s_waitcnt lgkmcnt(12)
    v_pk_add_f32 v[128:129], v[128:129], v[132:133]
    v_pk_add_f32 v[32:33], v[32:33], v[136:137]
    v_pk_add_f32 v[130:131], v[130:131], v[134:135]
    v_pk_add_f32 v[34:35], v[34:35], v[138:139]
    v_pk_add_f32 v[32:33], v[32:33], v[128:129]
    v_pk_add_f32 v[34:35], v[34:35], v[130:131]
    v_cvt_pk_bf16_f32 v52, v32, v33
    v_cvt_pk_bf16_f32 v53, v34, v35
    s_mov_b32 s51, 0
    buffer_store_dwordx2 v[52:53], v178, s[28:31], s51 offen
    s_waitcnt lgkmcnt(9)
    v_pk_add_f32 v[140:141], v[140:141], v[144:145]
    v_pk_add_f32 v[36:37], v[36:37], v[148:149]
    v_pk_add_f32 v[142:143], v[142:143], v[146:147]
    v_pk_add_f32 v[38:39], v[38:39], v[150:151]
    v_pk_add_f32 v[36:37], v[36:37], v[140:141]
    v_pk_add_f32 v[38:39], v[38:39], v[142:143]
    v_cvt_pk_bf16_f32 v54, v36, v37
    v_cvt_pk_bf16_f32 v55, v38, v39
    s_mov_b32 s51, 20480
    buffer_store_dwordx2 v[54:55], v178, s[28:31], s51 offen
    s_waitcnt lgkmcnt(6)
    v_pk_add_f32 v[152:153], v[152:153], v[156:157]
    v_pk_add_f32 v[40:41], v[40:41], v[192:193]
    v_pk_add_f32 v[154:155], v[154:155], v[158:159]
    v_pk_add_f32 v[42:43], v[42:43], v[194:195]
    v_pk_add_f32 v[40:41], v[40:41], v[152:153]
    v_pk_add_f32 v[42:43], v[42:43], v[154:155]
    v_cvt_pk_bf16_f32 v56, v40, v41
    v_cvt_pk_bf16_f32 v57, v42, v43
    s_mov_b32 s51, 40960
    buffer_store_dwordx2 v[56:57], v178, s[28:31], s51 offen
    s_waitcnt lgkmcnt(3)
    v_pk_add_f32 v[196:197], v[196:197], v[200:201]
    v_pk_add_f32 v[44:45], v[44:45], v[204:205]
    v_pk_add_f32 v[198:199], v[198:199], v[202:203]
    v_pk_add_f32 v[46:47], v[46:47], v[206:207]
    v_pk_add_f32 v[44:45], v[44:45], v[196:197]
    v_pk_add_f32 v[46:47], v[46:47], v[198:199]
    v_cvt_pk_bf16_f32 v58, v44, v45
    v_cvt_pk_bf16_f32 v59, v46, v47
    s_mov_b32 s51, 61440
    buffer_store_dwordx2 v[58:59], v178, s[28:31], s51 offen
    s_waitcnt lgkmcnt(0)
    v_pk_add_f32 v[208:209], v[208:209], v[212:213]
    v_pk_add_f32 v[48:49], v[48:49], v[216:217]
    v_pk_add_f32 v[210:211], v[210:211], v[214:215]
    v_pk_add_f32 v[50:51], v[50:51], v[218:219]
    v_pk_add_f32 v[48:49], v[48:49], v[208:209]
    v_pk_add_f32 v[50:51], v[50:51], v[210:211]
    v_cvt_pk_bf16_f32 v60, v48, v49
    v_cvt_pk_bf16_f32 v61, v50, v51
    s_mov_b32 s51, 81920
    buffer_store_dwordx2 v[60:61], v178, s[28:31], s51 offen
    s_endpgm
Lidle:
    s_sub_u32 s37, s54, 28
    s_lshl_b32 s55, s37, 3
    s_add_u32 s38, s55, s53
    s_waitcnt lgkmcnt(0)
    s_mov_b32 s24, s14
    s_and_b32 s25, s15, 0xffff
    s_mov_b32 s26, 8421376
    s_mov_b32 s27, 0x00020000
    s_mov_b32 s28, s10
    s_and_b32 s29, s11, 0xffff
    s_mov_b32 s30, 2621440
    s_mov_b32 s31, 0x00020000
    s_mov_b32 s32, s12
    s_and_b32 s33, s13, 0xffff
    s_mov_b32 s34, 256
    s_mov_b32 s35, 0x00020000
    s_mov_b32 s96, s8
    s_and_b32 s97, s9, 0xffff
    s_mov_b32 s98, 2211840
    s_mov_b32 s99, 0x00020000
    s_lshl_b32 s38, s53, 2
    s_add_u32 s38, s38, s37
    s_min_u32 s51, s38, 29
    s_mul_i32 s55, s51, 205
    s_lshr_b32 s55, s55, 11
    s_mul_i32 s56, s55, 10
    s_sub_u32 s56, s51, s56
    s_add_u32 s55, s55, 22
    s_lshl_b32 s39, s38, 2
    s_add_u32 s39, s39, s36
    s_cmp_lg_u32 s39, 124
    v_mov_b32 v32, 0
    v_mov_b32 v33, 0
    v_mov_b32 v34, 0
    v_mov_b32 v35, 0
    s_cbranch_scc1 Lnoclr0
    v_lshlrev_b32 v8, 4, v2
    s_mov_b32 s43, 8388608
    buffer_store_dwordx4 v[32:35], v8, s[24:27], s43 offen offset:0 sc1
    buffer_store_dwordx4 v[32:35], v8, s[24:27], s43 offen offset:1024 sc1
    buffer_store_dwordx4 v[32:35], v8, s[24:27], s43 offen offset:2048 sc1
    buffer_store_dwordx4 v[32:35], v8, s[24:27], s43 offen offset:3072 sc1
    s_add_u32 s43, s43, 4096
    buffer_store_dwordx4 v[32:35], v8, s[24:27], s43 offen offset:0 sc1
    buffer_store_dwordx4 v[32:35], v8, s[24:27], s43 offen offset:1024 sc1
    buffer_store_dwordx4 v[32:35], v8, s[24:27], s43 offen offset:2048 sc1
    buffer_store_dwordx4 v[32:35], v8, s[24:27], s43 offen offset:3072 sc1
    s_add_u32 s43, s43, 4096
    buffer_store_dwordx4 v[32:35], v8, s[24:27], s43 offen offset:0 sc1
    buffer_store_dwordx4 v[32:35], v8, s[24:27], s43 offen offset:1024 sc1
    buffer_store_dwordx4 v[32:35], v8, s[24:27], s43 offen offset:2048 sc1
    buffer_store_dwordx4 v[32:35], v8, s[24:27], s43 offen offset:3072 sc1
    s_add_u32 s43, s43, 4096
    buffer_store_dwordx4 v[32:35], v8, s[24:27], s43 offen offset:0 sc1
    buffer_store_dwordx4 v[32:35], v8, s[24:27], s43 offen offset:1024 sc1
    buffer_store_dwordx4 v[32:35], v8, s[24:27], s43 offen offset:2048 sc1
    buffer_store_dwordx4 v[32:35], v8, s[24:27], s43 offen offset:3072 sc1
    s_add_u32 s43, s43, 4096
    buffer_store_dwordx4 v[32:35], v8, s[24:27], s43 offen offset:0 sc1
    buffer_store_dwordx4 v[32:35], v8, s[24:27], s43 offen offset:1024 sc1
    buffer_store_dwordx4 v[32:35], v8, s[24:27], s43 offen offset:2048 sc1
    buffer_store_dwordx4 v[32:35], v8, s[24:27], s43 offen offset:3072 sc1
    s_add_u32 s43, s43, 4096
    buffer_store_dwordx4 v[32:35], v8, s[24:27], s43 offen offset:0 sc1
    buffer_store_dwordx4 v[32:35], v8, s[24:27], s43 offen offset:1024 sc1
    buffer_store_dwordx4 v[32:35], v8, s[24:27], s43 offen offset:2048 sc1
    buffer_store_dwordx4 v[32:35], v8, s[24:27], s43 offen offset:3072 sc1
    s_add_u32 s43, s43, 4096
    buffer_store_dwordx4 v[32:35], v8, s[24:27], s43 offen offset:0 sc1
    buffer_store_dwordx4 v[32:35], v8, s[24:27], s43 offen offset:1024 sc1
    buffer_store_dwordx4 v[32:35], v8, s[24:27], s43 offen offset:2048 sc1
    buffer_store_dwordx4 v[32:35], v8, s[24:27], s43 offen offset:3072 sc1
    s_add_u32 s43, s43, 4096
Lnoclr0:
    s_mov_b32 s20, s6
    s_and_b32 s21, s7, 0xffff
    s_mov_b32 s22, 2211840
    s_mov_b32 s23, 0x00020000
    s_lshl_b32 s40, s37, 2
    s_add_u32 s40, s40, s36
    s_mul_i32 s40, s40, 13824
    v_lshrrev_b32 v9, 4, v2
    v_mul_u32_u24 v9, 3456, v9
    v_and_b32 v10, 15, v2
    v_lshlrev_b32 v10, 4, v10
    v_add_u32 v9, v9, v10
    v_add_u32 v9, s40, v9
    s_and_b32 s41, s53, 1
    s_mul_i32 s42, s41, 1664
    s_mul_i32 s41, s41, 1792
    s_add_u32 s40, s41, 884736
    buffer_load_dwordx4 v[36:39], v9, s[20:23], s40 offen
    s_add_u32 s40, s41, 1990656
    buffer_load_dwordx4 v[40:43], v9, s[20:23], s40 offen
    s_add_u32 s40, s41, 1548544
    buffer_load_dwordx4 v[44:47], v9, s[20:23], s40 offen
    s_add_u32 s40, s41, 442624
    buffer_load_dwordx4 v[48:51], v9, s[20:23], s40 offen
    s_add_u32 s40, s41, 512
    buffer_load_dwordx4 v[52:55], v9, s[20:23], s40 offen
    s_add_u32 s40, s41, 1106432
    buffer_load_dwordx4 v[56:59], v9, s[20:23], s40 offen
    s_add_u32 s40, s41, 664320
    buffer_load_dwordx4 v[60:63], v9, s[20:23], s40 offen
    s_add_u32 s40, s41, 1770240
    buffer_load_dwordx4 v[64:67], v9, s[20:23], s40 offen
    s_add_u32 s40, s41, 1328128
    buffer_load_dwordx4 v[68:71], v9, s[20:23], s40 offen
    s_add_u32 s40, s41, 222208
    buffer_load_dwordx4 v[72:75], v9, s[20:23], s40 offen
    s_add_u32 s40, s41, 1991936
    buffer_load_dwordx4 v[76:79], v9, s[20:23], s40 offen
    s_add_u32 s40, s41, 886016
    buffer_load_dwordx4 v[80:83], v9, s[20:23], s40 offen
    s_add_u32 s40, s42, 443904
    buffer_load_dwordx4 v[84:87], v9, s[20:23], s40 offen
    s_add_u32 s40, s42, 1549824
    buffer_load_dwordx4 v[88:91], v9, s[20:23], s40 offen
    s_cmp_lg_u32 s39, 124
    s_cbranch_scc1 Lnoclr
    s_waitcnt vmcnt(14)
    v_mov_b32 v12, 1
    s_mov_b64 exec, 1
    buffer_store_dword v12, v32, s[32:35], 0 offen sc1
    s_mov_b64 exec, -1
Lnoclr:
    s_mul_i32 s57, s55, 36
    s_sub_u32 s57, s57, 767
    s_mul_i32 s46, s57, 54
    s_add_u32 s46, s46, s36
    s_lshl_b32 s46, s46, 10
    s_mul_i32 s45, s36, 40960
    s_lshl_b32 s58, s56, 7
    s_add_u32 s45, s45, s58
    s_cmp_lt_u32 s36, 2
    s_cselect_b32 s50, 0, 1073741824
    s_cselect_b32 s3, 0, -163840
    s_mul_i32 s48, s56, 1435
    s_lshr_b32 s48, s48, 10
    s_mul_i32 s58, s55, 5
    s_add_u32 s48, s48, s58
    s_mul_i32 s58, s48, 4682
    s_lshr_b32 s58, s58, 16
    s_mul_i32 s58, s58, 14
    s_sub_u32 s48, s48, s58
    s_mov_b32 s47, s48
    s_lshl_b32 s100, s36, 14
    s_add_u32 s100, s100, 98304
    s_mul_i32 s53, s36, 24576
    s_cmp_eq_u32 s36, 0
    s_cselect_b32 s54, 0, 1073741824
    v_lshlrev_b32 v17, 4, v2
    v_mov_b32 v166, v17
    v_add_u32 v167, 55296, v17
    v_add_u32 v168, 110592, v17
    v_add_u32 v169, 165888, v17
    v_add_u32 v170, 221184, v17
    v_add_u32 v171, 276480, v17
    v_lshrrev_b32 v12, 3, v2
    v_mul_u32_u24 v12, 1280, v12
    v_lshrrev_b32 v13, 4, v2
    v_bfe_u32 v14, v2, 1, 2
    v_xor_b32 v14, v14, v13
    v_lshlrev_b32 v14, 1, v14
    v_and_b32 v15, 1, v2
    v_or_b32 v14, v14, v15
    v_lshlrev_b32 v14, 4, v14
    v_add_u32 v181, v12, v14
    v_add_u32 v182, 9216, v181
    v_add_u32 v183, 18432, v181
    v_add_u32 v184, 27648, v181
    v_lshrrev_b32 v12, 2, v2
    v_lshlrev_b32 v12, 7, v12
    v_and_b32 v14, 3, v2
    v_lshlrev_b32 v14, 3, v14
    v_add_u32 v12, v12, v14
    v_bfe_u32 v13, v2, 3, 2
    s_add_u32 s58, s36, 0
    s_and_b32 s58, s58, 3
    v_xor_b32 v14, s58, v13
    v_lshlrev_b32 v14, 5, v14
    v_add_u32 v14, v12, v14
    v_add_u32 v185, s100, v14
    v_add_u32 v252, s53, v14
    s_add_u32 s58, s36, 1
    s_and_b32 s58, s58, 3
    v_xor_b32 v14, s58, v13
    v_lshlrev_b32 v14, 5, v14
    v_add_u32 v14, v12, v14
    v_add_u32 v186, s100, v14
    v_add_u32 v253, s53, v14
    s_mul_i32 s59, s58, 18432
    s_add_u32 s59, s59, 0
    v_add_u32 v174, s59, v17
    s_add_u32 s58, s36, 2
    s_and_b32 s58, s58, 3
    v_xor_b32 v14, s58, v13
    v_lshlrev_b32 v14, 5, v14
    v_add_u32 v14, v12, v14
    v_add_u32 v187, s100, v14
    v_add_u32 v254, s53, v14
    s_mul_i32 s59, s58, 18432
    s_add_u32 s59, s59, 6144
    v_add_u32 v175, s59, v17
    s_add_u32 s58, s36, 3
    s_and_b32 s58, s58, 3
    v_xor_b32 v14, s58, v13
    v_lshlrev_b32 v14, 5, v14
    v_add_u32 v14, v12, v14
    v_add_u32 v188, s100, v14
    v_add_u32 v255, s53, v14
    s_mul_i32 s59, s58, 18432
    s_add_u32 s59, s59, 12288
    v_add_u32 v176, s59, v17
    s_mul_i32 s59, s36, 18432
    v_add_u32 v177, s59, v17
    s_lshr_b32 s59, s57, 3
    s_add_u32 s58, s57, 5
    s_lshr_b32 s58, s58, 3
    s_cmp_eq_u32 s58, s59
    s_cselect_b32 s58, 13, 27
    s_mul_i32 s59, s59, 14
    v_min_u32 v12, s58, v2
    v_add_u32 v12, s59, v12
    v_lshlrev_b32 v12, 7, v12
    v_add_u32 v172, 8388608, v12
    s_lshl_b32 s59, s57, 4
    v_and_b32 v178, 15, v2
    v_add_u32 v178, s59, v178
    v_mul_u32_u24 v178, 1280, v178
    v_lshrrev_b32 v11, 4, v2
    v_lshlrev_b32 v11, 3, v11
    v_add_u32 v178, v178, v11
    s_lshl_b32 s59, s56, 7
    s_lshl_b32 s58, s36, 5
    s_add_u32 s59, s59, s58
    v_add_u32 v178, s59, v178
    v_mov_b32 v179, 1
    v_mov_b32 v180, 0
    s_cmp_ge_u32 s38, 30
    s_cbranch_scc1 Lexitw
    s_add_u32 m0, s100, 0
    s_mul_i32 s51, s47, 163840
    s_add_u32 s51, s51, s45
    s_cmp_eq_u32 s47, 13
    s_cselect_b32 s52, s3, 0
    s_add_u32 s51, s51, s52
    s_add_u32 s47, s47, 1
    s_cmp_eq_u32 s47, 14
    s_cselect_b32 s47, 0, s47
    buffer_load_dwordx4 v181, s[96:99], s51 offen offset:0 lds
    buffer_load_dwordx4 v182, s[96:99], s51 offen offset:1024 lds
    buffer_load_dwordx4 v183, s[96:99], s51 offen offset:2048 lds
    buffer_load_dwordx4 v184, s[96:99], s51 offen offset:3072 lds
    s_add_u32 m0, s100, 4096
    s_mul_i32 s51, s47, 163840
    s_add_u32 s51, s51, s45
    s_cmp_eq_u32 s47, 13
    s_cselect_b32 s52, s3, 0
    s_add_u32 s51, s51, s52
    s_add_u32 s47, s47, 1
    s_cmp_eq_u32 s47, 14
    s_cselect_b32 s47, 0, s47
    buffer_load_dwordx4 v181, s[96:99], s51 offen offset:0 lds
    buffer_load_dwordx4 v182, s[96:99], s51 offen offset:1024 lds
    buffer_load_dwordx4 v183, s[96:99], s51 offen offset:2048 lds
    buffer_load_dwordx4 v184, s[96:99], s51 offen offset:3072 lds
    s_add_u32 m0, s100, 8192
    s_mul_i32 s51, s47, 163840
    s_add_u32 s51, s51, s45
    s_cmp_eq_u32 s47, 13
    s_cselect_b32 s52, s3, 0
    s_add_u32 s51, s51, s52
    s_add_u32 s47, s47, 1
    s_cmp_eq_u32 s47, 14
    s_cselect_b32 s47, 0, s47
    buffer_load_dwordx4 v181, s[96:99], s51 offen offset:0 lds
    buffer_load_dwordx4 v182, s[96:99], s51 offen offset:1024 lds
    buffer_load_dwordx4 v183, s[96:99], s51 offen offset:2048 lds
    buffer_load_dwordx4 v184, s[96:99], s51 offen offset:3072 lds
    s_add_u32 m0, s100, 12288
    s_mul_i32 s51, s47, 163840
    s_add_u32 s51, s51, s45
    s_cmp_eq_u32 s47, 13
    s_cselect_b32 s52, s3, 0
    s_add_u32 s51, s51, s52
    s_add_u32 s47, s47, 1
    s_cmp_eq_u32 s47, 14
    s_cselect_b32 s47, 0, s47
    buffer_load_dwordx4 v181, s[96:99], s51 offen offset:0 lds
    buffer_load_dwordx4 v182, s[96:99], s51 offen offset:1024 lds
    buffer_load_dwordx4 v183, s[96:99], s51 offen offset:2048 lds
    buffer_load_dwordx4 v184, s[96:99], s51 offen offset:3072 lds
    s_add_u32 m0, s53, 0
    s_mul_i32 s51, s47, 163840
    s_add_u32 s51, s51, s45
    s_cmp_eq_u32 s47, 13
    s_cselect_b32 s52, s3, 0
    s_add_u32 s51, s51, s52
    s_add_u32 s47, s47, 1
    s_cmp_eq_u32 s47, 14
    s_cselect_b32 s47, 0, s47
    buffer_load_dwordx4 v181, s[96:99], s51 offen offset:0 lds
    buffer_load_dwordx4 v182, s[96:99], s51 offen offset:1024 lds
    buffer_load_dwordx4 v183, s[96:99], s51 offen offset:2048 lds
    buffer_load_dwordx4 v184, s[96:99], s51 offen offset:3072 lds
    s_add_u32 m0, s53, 4096
    s_mul_i32 s51, s47, 163840
    s_add_u32 s51, s51, s45
    s_cmp_eq_u32 s47, 13
    s_cselect_b32 s52, s3, 0
    s_add_u32 s51, s51, s52
    s_add_u32 s47, s47, 1
    s_cmp_eq_u32 s47, 14
    s_cselect_b32 s47, 0, s47
    buffer_load_dwordx4 v181, s[96:99], s51 offen offset:0 lds
    buffer_load_dwordx4 v182, s[96:99], s51 offen offset:1024 lds
    buffer_load_dwordx4 v183, s[96:99], s51 offen offset:2048 lds
    buffer_load_dwordx4 v184, s[96:99], s51 offen offset:3072 lds
    s_add_u32 m0, s53, 8192
    s_mul_i32 s51, s47, 163840
    s_add_u32 s51, s51, s45
    s_cmp_eq_u32 s47, 13
    s_cselect_b32 s52, s3, 0
    s_add_u32 s51, s51, s52
    s_add_u32 s47, s47, 1
    s_cmp_eq_u32 s47, 14
    s_cselect_b32 s47, 0, s47
    buffer_load_dwordx4 v181, s[96:99], s51 offen offset:0 lds
    buffer_load_dwordx4 v182, s[96:99], s51 offen offset:1024 lds
    buffer_load_dwordx4 v183, s[96:99], s51 offen offset:2048 lds
    buffer_load_dwordx4 v184, s[96:99], s51 offen offset:3072 lds
    s_add_u32 m0, s53, 12288
    s_mul_i32 s51, s47, 163840
    s_add_u32 s51, s51, s45
    s_cmp_eq_u32 s47, 13
    s_cselect_b32 s52, s3, 0
    s_add_u32 s51, s51, s52
    s_add_u32 s47, s47, 1
    s_cmp_eq_u32 s47, 14
    s_cselect_b32 s47, 0, s47
    buffer_load_dwordx4 v181, s[96:99], s51 offen offset:0 lds
    buffer_load_dwordx4 v182, s[96:99], s51 offen offset:1024 lds
    buffer_load_dwordx4 v183, s[96:99], s51 offen offset:2048 lds
    buffer_load_dwordx4 v184, s[96:99], s51 offen offset:3072 lds
    s_add_u32 m0, s53, 16384
    s_mul_i32 s51, s47, 163840
    s_add_u32 s51, s51, s45
    s_cmp_eq_u32 s47, 13
    s_cselect_b32 s52, s3, 0
    s_add_u32 s51, s51, s52
    s_add_u32 s47, s47, 1
    s_cmp_eq_u32 s47, 14
    s_cselect_b32 s47, 0, s47
    buffer_load_dwordx4 v181, s[96:99], s51 offen offset:0 lds
    buffer_load_dwordx4 v182, s[96:99], s51 offen offset:1024 lds
    buffer_load_dwordx4 v183, s[96:99], s51 offen offset:2048 lds
    buffer_load_dwordx4 v184, s[96:99], s51 offen offset:3072 lds
    s_add_u32 m0, s53, 20480
    s_mul_i32 s51, s47, 163840
    s_add_u32 s51, s51, s45
    s_cmp_eq_u32 s47, 13
    s_cselect_b32 s52, s3, 0
    s_add_u32 s51, s51, s52
    s_add_u32 s47, s47, 1
    s_cmp_eq_u32 s47, 14
    s_cselect_b32 s47, 0, s47
    buffer_load_dwordx4 v181, s[96:99], s51 offen offset:0 lds
    buffer_load_dwordx4 v182, s[96:99], s51 offen offset:1024 lds
    buffer_load_dwordx4 v183, s[96:99], s51 offen offset:2048 lds
    buffer_load_dwordx4 v184, s[96:99], s51 offen offset:3072 lds
    s_waitcnt vmcnt(36)
    ds_read_b64_tr_b16 a[0:1], v185 offset:0
    ds_read_b64_tr_b16 a[2:3], v185 offset:2048
    ds_read_b64_tr_b16 a[4:5], v186 offset:0
    ds_read_b64_tr_b16 a[6:7], v186 offset:2048
    ds_read_b64_tr_b16 a[8:9], v187 offset:0
    ds_read_b64_tr_b16 a[10:11], v187 offset:2048
    ds_read_b64_tr_b16 a[12:13], v188 offset:0
    ds_read_b64_tr_b16 a[14:15], v188 offset:2048
    s_waitcnt vmcnt(32)
    ds_read_b64_tr_b16 a[16:17], v185 offset:4096
    ds_read_b64_tr_b16 a[18:19], v185 offset:6144
    ds_read_b64_tr_b16 a[20:21], v186 offset:4096
    ds_read_b64_tr_b16 a[22:23], v186 offset:6144
    ds_read_b64_tr_b16 a[24:25], v187 offset:4096
    ds_read_b64_tr_b16 a[26:27], v187 offset:6144
    ds_read_b64_tr_b16 a[28:29], v188 offset:4096
    ds_read_b64_tr_b16 a[30:31], v188 offset:6144
    s_waitcnt vmcnt(28)
    ds_read_b64_tr_b16 a[32:33], v185 offset:8192
    ds_read_b64_tr_b16 a[34:35], v185 offset:10240
    ds_read_b64_tr_b16 a[36:37], v186 offset:8192
    ds_read_b64_tr_b16 a[38:39], v186 offset:10240
    ds_read_b64_tr_b16 a[40:41], v187 offset:8192
    ds_read_b64_tr_b16 a[42:43], v187 offset:10240
    ds_read_b64_tr_b16 a[44:45], v188 offset:8192
    ds_read_b64_tr_b16 a[46:47], v188 offset:10240
    s_waitcnt vmcnt(24)
    ds_read_b64_tr_b16 a[48:49], v185 offset:12288
    ds_read_b64_tr_b16 a[50:51], v185 offset:14336
    ds_read_b64_tr_b16 a[52:53], v186 offset:12288
    ds_read_b64_tr_b16 a[54:55], v186 offset:14336
    ds_read_b64_tr_b16 a[56:57], v187 offset:12288
    ds_read_b64_tr_b16 a[58:59], v187 offset:14336
    ds_read_b64_tr_b16 a[60:61], v188 offset:12288
    ds_read_b64_tr_b16 a[62:63], v188 offset:14336
    s_waitcnt lgkmcnt(15)
    s_add_u32 m0, s100, 0
    s_mul_i32 s51, s47, 163840
    s_add_u32 s51, s51, s45
    s_cmp_eq_u32 s47, 13
    s_cselect_b32 s52, s3, 0
    s_add_u32 s51, s51, s52
    s_add_u32 s47, s47, 1
    s_cmp_eq_u32 s47, 14
    s_cselect_b32 s47, 0, s47
    buffer_load_dwordx4 v181, s[96:99], s51 offen offset:0 lds
    buffer_load_dwordx4 v182, s[96:99], s51 offen offset:1024 lds
    buffer_load_dwordx4 v183, s[96:99], s51 offen offset:2048 lds
    buffer_load_dwordx4 v184, s[96:99], s51 offen offset:3072 lds
    s_waitcnt lgkmcnt(15)
    s_add_u32 m0, s100, 4096
    s_mul_i32 s51, s47, 163840
    s_add_u32 s51, s51, s45
    s_cmp_eq_u32 s47, 13
    s_cselect_b32 s52, s3, 0
    s_add_u32 s51, s51, s52
    s_add_u32 s47, s47, 1
    s_cmp_eq_u32 s47, 14
    s_cselect_b32 s47, 0, s47
    buffer_load_dwordx4 v181, s[96:99], s51 offen offset:0 lds
    buffer_load_dwordx4 v182, s[96:99], s51 offen offset:1024 lds
    buffer_load_dwordx4 v183, s[96:99], s51 offen offset:2048 lds
    buffer_load_dwordx4 v184, s[96:99], s51 offen offset:3072 lds
    s_waitcnt lgkmcnt(8)
    s_add_u32 m0, s100, 8192
    s_mul_i32 s51, s47, 163840
    s_add_u32 s51, s51, s45
    s_cmp_eq_u32 s47, 13
    s_cselect_b32 s52, s3, 0
    s_add_u32 s51, s51, s52
    s_add_u32 s47, s47, 1
    s_cmp_eq_u32 s47, 14
    s_cselect_b32 s47, 0, s47
    buffer_load_dwordx4 v181, s[96:99], s51 offen offset:0 lds
    buffer_load_dwordx4 v182, s[96:99], s51 offen offset:1024 lds
    buffer_load_dwordx4 v183, s[96:99], s51 offen offset:2048 lds
    buffer_load_dwordx4 v184, s[96:99], s51 offen offset:3072 lds
    s_waitcnt lgkmcnt(0)
    s_add_u32 m0, s100, 12288
    s_mul_i32 s51, s47, 163840
    s_add_u32 s51, s51, s45
    s_cmp_eq_u32 s47, 13
    s_cselect_b32 s52, s3, 0
    s_add_u32 s51, s51, s52
    s_add_u32 s47, s47, 1
    s_cmp_eq_u32 s47, 14
    s_cselect_b32 s47, 0, s47
    buffer_load_dwordx4 v181, s[96:99], s51 offen offset:0 lds
    buffer_load_dwordx4 v182, s[96:99], s51 offen offset:1024 lds
    buffer_load_dwordx4 v183, s[96:99], s51 offen offset:2048 lds
    buffer_load_dwordx4 v184, s[96:99], s51 offen offset:3072 lds
    v_mul_u32_u24 v24, 1280, v2
    s_and_b32 s4, s2, 7
    s_lshl_b32 s4, s4, 2
    s_add_u32 s4, s4, 4
    s_lshl_b32 s5, s37, 2
    s_add_u32 s5, s5, s36
    s_mul_i32 s5, s5, 2
    s_mul_i32 s6, s5, 43
    s_lshr_b32 s6, s6, 8
    s_mul_i32 s7, s6, 6
    s_sub_u32 s7, s5, s7
    s_add_u32 s7, s7, s4
    s_mul_i32 s8, s7, 205
    s_lshr_b32 s8, s8, 11
    s_mul_i32 s8, s8, 10
    s_sub_u32 s7, s7, s8
    s_lshl_b32 s7, s7, 7
    s_mul_i32 s6, s6, 327680
    s_add_u32 s6, s6, s7
    buffer_load_dword v16, v24, s[96:99], s6 offen
    s_add_u32 s5, s5, 1
    s_mul_i32 s6, s5, 43
    s_lshr_b32 s6, s6, 8
    s_mul_i32 s7, s6, 6
    s_sub_u32 s7, s5, s7
    s_add_u32 s7, s7, s4
    s_mul_i32 s8, s7, 205
    s_lshr_b32 s8, s8, 11
    s_mul_i32 s8, s8, 10
    s_sub_u32 s7, s7, s8
    s_lshl_b32 s7, s7, 7
    s_mul_i32 s6, s6, 327680
    s_add_u32 s6, s6, s7
    buffer_load_dword v17, v24, s[96:99], s6 offen
    s_add_u32 s5, s5, 1
    s_waitcnt vmcnt(38)
    ds_read_b64_tr_b16 a[64:65], v252 offset:0
    ds_read_b64_tr_b16 a[66:67], v252 offset:2048
    ds_read_b64_tr_b16 a[68:69], v253 offset:0
    ds_read_b64_tr_b16 a[70:71], v253 offset:2048
    ds_read_b64_tr_b16 a[72:73], v254 offset:0
    ds_read_b64_tr_b16 a[74:75], v254 offset:2048
    ds_read_b64_tr_b16 a[76:77], v255 offset:0
    ds_read_b64_tr_b16 a[78:79], v255 offset:2048
    s_waitcnt vmcnt(34)
    ds_read_b64_tr_b16 a[80:81], v252 offset:4096
    ds_read_b64_tr_b16 a[82:83], v252 offset:6144
    ds_read_b64_tr_b16 a[84:85], v253 offset:4096
    ds_read_b64_tr_b16 a[86:87], v253 offset:6144
    ds_read_b64_tr_b16 a[88:89], v254 offset:4096
    ds_read_b64_tr_b16 a[90:91], v254 offset:6144
    ds_read_b64_tr_b16 a[92:93], v255 offset:4096
    ds_read_b64_tr_b16 a[94:95], v255 offset:6144
    s_waitcnt vmcnt(30)
    ds_read_b64_tr_b16 a[96:97], v252 offset:8192
    ds_read_b64_tr_b16 a[98:99], v252 offset:10240
    ds_read_b64_tr_b16 a[100:101], v253 offset:8192
    ds_read_b64_tr_b16 a[102:103], v253 offset:10240
    ds_read_b64_tr_b16 a[104:105], v254 offset:8192
    ds_read_b64_tr_b16 a[106:107], v254 offset:10240
    ds_read_b64_tr_b16 a[108:109], v255 offset:8192
    ds_read_b64_tr_b16 a[110:111], v255 offset:10240
    s_waitcnt vmcnt(26)
    ds_read_b64_tr_b16 a[112:113], v252 offset:12288
    ds_read_b64_tr_b16 a[114:115], v252 offset:14336
    ds_read_b64_tr_b16 a[116:117], v253 offset:12288
    ds_read_b64_tr_b16 a[118:119], v253 offset:14336
    ds_read_b64_tr_b16 a[120:121], v254 offset:12288
    ds_read_b64_tr_b16 a[122:123], v254 offset:14336
    ds_read_b64_tr_b16 a[124:125], v255 offset:12288
    ds_read_b64_tr_b16 a[126:127], v255 offset:14336
    s_waitcnt vmcnt(22)
    ds_read_b64_tr_b16 a[128:129], v252 offset:16384
    ds_read_b64_tr_b16 a[130:131], v252 offset:18432
    ds_read_b64_tr_b16 a[132:133], v253 offset:16384
    ds_read_b64_tr_b16 a[134:135], v253 offset:18432
    ds_read_b64_tr_b16 a[136:137], v254 offset:16384
    ds_read_b64_tr_b16 a[138:139], v254 offset:18432
    ds_read_b64_tr_b16 a[140:141], v255 offset:16384
    ds_read_b64_tr_b16 a[142:143], v255 offset:18432
    s_waitcnt vmcnt(18)
    ds_read_b64_tr_b16 a[144:145], v252 offset:20480
    ds_read_b64_tr_b16 a[146:147], v252 offset:22528
    ds_read_b64_tr_b16 a[148:149], v253 offset:20480
    ds_read_b64_tr_b16 a[150:151], v253 offset:22528
    ds_read_b64_tr_b16 a[152:153], v254 offset:20480
    ds_read_b64_tr_b16 a[154:155], v254 offset:22528
    ds_read_b64_tr_b16 a[156:157], v255 offset:20480
    ds_read_b64_tr_b16 a[158:159], v255 offset:22528
    s_waitcnt vmcnt(14)
    ds_read_b64_tr_b16 a[160:161], v185 offset:0
    ds_read_b64_tr_b16 a[162:163], v185 offset:2048
    ds_read_b64_tr_b16 a[164:165], v186 offset:0
    ds_read_b64_tr_b16 a[166:167], v186 offset:2048
    ds_read_b64_tr_b16 a[168:169], v187 offset:0
    ds_read_b64_tr_b16 a[170:171], v187 offset:2048
    ds_read_b64_tr_b16 a[172:173], v188 offset:0
    ds_read_b64_tr_b16 a[174:175], v188 offset:2048
    s_waitcnt vmcnt(10)
    ds_read_b64_tr_b16 a[176:177], v185 offset:4096
    ds_read_b64_tr_b16 a[178:179], v185 offset:6144
    ds_read_b64_tr_b16 a[180:181], v186 offset:4096
    ds_read_b64_tr_b16 a[182:183], v186 offset:6144
    ds_read_b64_tr_b16 a[184:185], v187 offset:4096
    ds_read_b64_tr_b16 a[186:187], v187 offset:6144
    ds_read_b64_tr_b16 a[188:189], v188 offset:4096
    ds_read_b64_tr_b16 a[190:191], v188 offset:6144
    s_waitcnt vmcnt(6)
    ds_read_b64_tr_b16 a[192:193], v185 offset:8192
    ds_read_b64_tr_b16 a[194:195], v185 offset:10240
    ds_read_b64_tr_b16 a[196:197], v186 offset:8192
    ds_read_b64_tr_b16 a[198:199], v186 offset:10240
    ds_read_b64_tr_b16 a[200:201], v187 offset:8192
    ds_read_b64_tr_b16 a[202:203], v187 offset:10240
    ds_read_b64_tr_b16 a[204:205], v188 offset:8192
    ds_read_b64_tr_b16 a[206:207], v188 offset:10240
    s_waitcnt vmcnt(2)
    ds_read_b64_tr_b16 a[208:209], v185 offset:12288
    ds_read_b64_tr_b16 a[210:211], v185 offset:14336
    ds_read_b64_tr_b16 a[212:213], v186 offset:12288
    ds_read_b64_tr_b16 a[214:215], v186 offset:14336
    ds_read_b64_tr_b16 a[216:217], v187 offset:12288
    ds_read_b64_tr_b16 a[218:219], v187 offset:14336
    ds_read_b64_tr_b16 a[220:221], v188 offset:12288
    ds_read_b64_tr_b16 a[222:223], v188 offset:14336
    s_cmp_lg_u32 s36, 0
    s_cbranch_scc1 Lgo_6
    s_mov_b32 s59, 0x40000
Lspin3:
    buffer_load_dword v173, v180, s[32:35], 0 offen sc1
    s_waitcnt vmcnt(0)
Lspinc3:
    v_cmp_eq_u32 vcc, 1, v173
    s_cmp_eq_u64 vcc, -1
    s_cbranch_scc1 Lspun3
    s_sleep 1
    s_sub_u32 s59, s59, 1
    s_cmp_lg_u32 s59, 0
    s_cbranch_scc1 Lspin3
Lspun3:
    s_mov_b32 s59, 0x40000
Lspin4:
    buffer_load_dwordx4 v[28:31], v172, s[24:27], 0 offen sc1
    s_waitcnt vmcnt(0)
Lspinc4:
    v_and_b32 v173, v28, v29
    v_and_b32 v173, v173, v30
    v_and_b32 v173, v173, v31
    v_cmp_eq_u32 vcc, 1, v173
    s_cmp_eq_u64 vcc, -1
    s_cbranch_scc1 Lspun4
    s_sleep 10
    s_sub_u32 s59, s59, 1
    s_cmp_lg_u32 s59, 0
    s_cbranch_scc1 Lspin4
Lspun4:
Lgo_6:
    s_barrier
    s_mov_b32 s49, s47
    s_mov_b32 s47, s48
    s_mul_i32 s51, s47, 4096
    s_add_u32 s51, s51, s46
    s_cmp_eq_u32 s47, 13
    s_cselect_b32 s52, s50, 0
    s_add_u32 s51, s51, s52
    s_add_u32 s47, s47, 1
    s_cmp_eq_u32 s47, 14
    s_cselect_b32 s47, 0, s47
    buffer_load_dwordx4 v[128:131], v166, s[24:27], s51 offen sc1
    buffer_load_dwordx4 v[132:135], v167, s[24:27], s51 offen sc1
    buffer_load_dwordx4 v[136:139], v168, s[24:27], s51 offen sc1
    buffer_load_dwordx4 v[140:143], v169, s[24:27], s51 offen sc1
    buffer_load_dwordx4 v[144:147], v170, s[24:27], s51 offen sc1
    buffer_load_dwordx4 v[148:151], v171, s[24:27], s51 offen sc1
    s_mul_i32 s51, s47, 4096
    s_add_u32 s51, s51, s46
    s_cmp_eq_u32 s47, 13
    s_cselect_b32 s52, s50, 0
    s_add_u32 s51, s51, s52
    s_add_u32 s47, s47, 1
    s_cmp_eq_u32 s47, 14
    s_cselect_b32 s47, 0, s47
    buffer_load_dwordx4 v[192:195], v166, s[24:27], s51 offen sc1
    buffer_load_dwordx4 v[196:199], v167, s[24:27], s51 offen sc1
    buffer_load_dwordx4 v[200:203], v168, s[24:27], s51 offen sc1
    buffer_load_dwordx4 v[204:207], v169, s[24:27], s51 offen sc1
    buffer_load_dwordx4 v[208:211], v170, s[24:27], s51 offen sc1
    buffer_load_dwordx4 v[212:215], v171, s[24:27], s51 offen sc1
    s_mul_i32 s51, s47, 4096
    s_add_u32 s51, s51, s46
    s_cmp_eq_u32 s47, 13
    s_cselect_b32 s52, s50, 0
    s_add_u32 s51, s51, s52
    s_add_u32 s47, s47, 1
    s_cmp_eq_u32 s47, 14
    s_cselect_b32 s47, 0, s47
    buffer_load_dwordx4 v[216:219], v166, s[24:27], s51 offen sc1
    buffer_load_dwordx4 v[220:223], v167, s[24:27], s51 offen sc1
    buffer_load_dwordx4 v[224:227], v168, s[24:27], s51 offen sc1
    buffer_load_dwordx4 v[228:231], v169, s[24:27], s51 offen sc1
    buffer_load_dwordx4 v[232:235], v170, s[24:27], s51 offen sc1
    buffer_load_dwordx4 v[236:239], v171, s[24:27], s51 offen sc1
    s_waitcnt lgkmcnt(0)
    s_waitcnt vmcnt(12)
    v_mfma_f32_16x16x32_bf16 v[32:35], a[0:3], v[128:131], 0
    s_mul_i32 s51, s47, 4096
    s_add_u32 s51, s51, s46
    v_mfma_f32_16x16x32_bf16 v[36:39], a[0:3], v[132:135], 0
    s_cmp_eq_u32 s47, 13
    s_cselect_b32 s52, s50, 0
    v_mfma_f32_16x16x32_bf16 v[40:43], a[0:3], v[136:139], 0
    s_add_u32 s51, s51, s52
    s_add_u32 s47, s47, 1
    v_mfma_f32_16x16x32_bf16 v[44:47], a[0:3], v[140:143], 0
    s_cmp_eq_u32 s47, 14
    s_cselect_b32 s47, 0, s47
    v_mfma_f32_16x16x32_bf16 v[48:51], a[0:3], v[144:147], 0
    buffer_load_dwordx4 a[224:227], v166, s[24:27], s51 offen sc1
    v_mfma_f32_16x16x32_bf16 v[52:55], a[0:3], v[148:151], 0
    v_mfma_f32_16x16x32_bf16 v[56:59], a[4:7], v[128:131], 0
    v_mfma_f32_16x16x32_bf16 v[60:63], a[4:7], v[132:135], 0
    buffer_load_dwordx4 a[228:231], v167, s[24:27], s51 offen sc1
    v_mfma_f32_16x16x32_bf16 v[64:67], a[4:7], v[136:139], 0
    v_mfma_f32_16x16x32_bf16 v[68:71], a[4:7], v[140:143], 0
    v_mfma_f32_16x16x32_bf16 v[72:75], a[4:7], v[144:147], 0
    buffer_load_dwordx4 a[232:235], v168, s[24:27], s51 offen sc1
    v_mfma_f32_16x16x32_bf16 v[76:79], a[4:7], v[148:151], 0
    v_mfma_f32_16x16x32_bf16 v[80:83], a[8:11], v[128:131], 0
    v_mfma_f32_16x16x32_bf16 v[84:87], a[8:11], v[132:135], 0
    buffer_load_dwordx4 a[236:239], v169, s[24:27], s51 offen sc1
    v_mfma_f32_16x16x32_bf16 v[88:91], a[8:11], v[136:139], 0
    v_mfma_f32_16x16x32_bf16 v[92:95], a[8:11], v[140:143], 0
    v_mfma_f32_16x16x32_bf16 v[96:99], a[8:11], v[144:147], 0
    buffer_load_dwordx4 a[240:243], v170, s[24:27], s51 offen sc1
    v_mfma_f32_16x16x32_bf16 v[100:103], a[8:11], v[148:151], 0
    v_mfma_f32_16x16x32_bf16 v[104:107], a[12:15], v[128:131], 0
    v_mfma_f32_16x16x32_bf16 v[108:111], a[12:15], v[132:135], 0
    buffer_load_dwordx4 a[244:247], v171, s[24:27], s51 offen sc1
    v_mfma_f32_16x16x32_bf16 v[112:115], a[12:15], v[136:139], 0
    v_mfma_f32_16x16x32_bf16 v[116:119], a[12:15], v[140:143], 0
    v_mfma_f32_16x16x32_bf16 v[120:123], a[12:15], v[144:147], 0
    v_mfma_f32_16x16x32_bf16 v[124:127], a[12:15], v[148:151], 0
    s_waitcnt vmcnt(12)
    v_mfma_f32_16x16x32_bf16 v[32:35], a[16:19], v[192:195], v[32:35]
    s_mul_i32 s51, s47, 4096
    s_add_u32 s51, s51, s46
    v_mfma_f32_16x16x32_bf16 v[36:39], a[16:19], v[196:199], v[36:39]
    s_cmp_eq_u32 s47, 13
    s_cselect_b32 s52, s50, 0
    v_mfma_f32_16x16x32_bf16 v[40:43], a[16:19], v[200:203], v[40:43]
    s_add_u32 s51, s51, s52
    s_add_u32 s47, s47, 1
    v_mfma_f32_16x16x32_bf16 v[44:47], a[16:19], v[204:207], v[44:47]
    s_cmp_eq_u32 s47, 14
    s_cselect_b32 s47, 0, s47
    v_mfma_f32_16x16x32_bf16 v[48:51], a[16:19], v[208:211], v[48:51]
    buffer_load_dwordx4 v[128:131], v166, s[24:27], s51 offen sc1
    v_mfma_f32_16x16x32_bf16 v[52:55], a[16:19], v[212:215], v[52:55]
    v_mfma_f32_16x16x32_bf16 v[56:59], a[20:23], v[192:195], v[56:59]
    v_mfma_f32_16x16x32_bf16 v[60:63], a[20:23], v[196:199], v[60:63]
    buffer_load_dwordx4 v[132:135], v167, s[24:27], s51 offen sc1
    v_mfma_f32_16x16x32_bf16 v[64:67], a[20:23], v[200:203], v[64:67]
    v_mfma_f32_16x16x32_bf16 v[68:71], a[20:23], v[204:207], v[68:71]
    v_mfma_f32_16x16x32_bf16 v[72:75], a[20:23], v[208:211], v[72:75]
    buffer_load_dwordx4 v[136:139], v168, s[24:27], s51 offen sc1
    v_mfma_f32_16x16x32_bf16 v[76:79], a[20:23], v[212:215], v[76:79]
    v_mfma_f32_16x16x32_bf16 v[80:83], a[24:27], v[192:195], v[80:83]
    v_mfma_f32_16x16x32_bf16 v[84:87], a[24:27], v[196:199], v[84:87]
    buffer_load_dwordx4 v[140:143], v169, s[24:27], s51 offen sc1
    v_mfma_f32_16x16x32_bf16 v[88:91], a[24:27], v[200:203], v[88:91]
    v_mfma_f32_16x16x32_bf16 v[92:95], a[24:27], v[204:207], v[92:95]
    v_mfma_f32_16x16x32_bf16 v[96:99], a[24:27], v[208:211], v[96:99]
    buffer_load_dwordx4 v[144:147], v170, s[24:27], s51 offen sc1
    v_mfma_f32_16x16x32_bf16 v[100:103], a[24:27], v[212:215], v[100:103]
    v_mfma_f32_16x16x32_bf16 v[104:107], a[28:31], v[192:195], v[104:107]
    v_mfma_f32_16x16x32_bf16 v[108:111], a[28:31], v[196:199], v[108:111]
    buffer_load_dwordx4 v[148:151], v171, s[24:27], s51 offen sc1
    v_mfma_f32_16x16x32_bf16 v[112:115], a[28:31], v[200:203], v[112:115]
    v_mfma_f32_16x16x32_bf16 v[116:119], a[28:31], v[204:207], v[116:119]
    v_mfma_f32_16x16x32_bf16 v[120:123], a[28:31], v[208:211], v[120:123]
    v_mfma_f32_16x16x32_bf16 v[124:127], a[28:31], v[212:215], v[124:127]
    s_waitcnt vmcnt(12)
    v_mfma_f32_16x16x32_bf16 v[32:35], a[32:35], v[216:219], v[32:35]
    s_mul_i32 s51, s47, 4096
    s_add_u32 s51, s51, s46
    v_mfma_f32_16x16x32_bf16 v[36:39], a[32:35], v[220:223], v[36:39]
    s_cmp_eq_u32 s47, 13
    s_cselect_b32 s52, s50, 0
    v_mfma_f32_16x16x32_bf16 v[40:43], a[32:35], v[224:227], v[40:43]
    s_add_u32 s51, s51, s52
    s_add_u32 s47, s47, 1
    v_mfma_f32_16x16x32_bf16 v[44:47], a[32:35], v[228:231], v[44:47]
    s_cmp_eq_u32 s47, 14
    s_cselect_b32 s47, 0, s47
    v_mfma_f32_16x16x32_bf16 v[48:51], a[32:35], v[232:235], v[48:51]
    buffer_load_dwordx4 v[192:195], v166, s[24:27], s51 offen sc1
    v_mfma_f32_16x16x32_bf16 v[52:55], a[32:35], v[236:239], v[52:55]
    v_mfma_f32_16x16x32_bf16 v[56:59], a[36:39], v[216:219], v[56:59]
    v_mfma_f32_16x16x32_bf16 v[60:63], a[36:39], v[220:223], v[60:63]
    buffer_load_dwordx4 v[196:199], v167, s[24:27], s51 offen sc1
    v_mfma_f32_16x16x32_bf16 v[64:67], a[36:39], v[224:227], v[64:67]
    v_mfma_f32_16x16x32_bf16 v[68:71], a[36:39], v[228:231], v[68:71]
    v_mfma_f32_16x16x32_bf16 v[72:75], a[36:39], v[232:235], v[72:75]
    buffer_load_dwordx4 v[200:203], v168, s[24:27], s51 offen sc1
    v_mfma_f32_16x16x32_bf16 v[76:79], a[36:39], v[236:239], v[76:79]
    v_mfma_f32_16x16x32_bf16 v[80:83], a[40:43], v[216:219], v[80:83]
    v_mfma_f32_16x16x32_bf16 v[84:87], a[40:43], v[220:223], v[84:87]
    buffer_load_dwordx4 v[204:207], v169, s[24:27], s51 offen sc1
    v_mfma_f32_16x16x32_bf16 v[88:91], a[40:43], v[224:227], v[88:91]
    v_mfma_f32_16x16x32_bf16 v[92:95], a[40:43], v[228:231], v[92:95]
    v_mfma_f32_16x16x32_bf16 v[96:99], a[40:43], v[232:235], v[96:99]
    buffer_load_dwordx4 v[208:211], v170, s[24:27], s51 offen sc1
    v_mfma_f32_16x16x32_bf16 v[100:103], a[40:43], v[236:239], v[100:103]
    v_mfma_f32_16x16x32_bf16 v[104:107], a[44:47], v[216:219], v[104:107]
    v_mfma_f32_16x16x32_bf16 v[108:111], a[44:47], v[220:223], v[108:111]
    buffer_load_dwordx4 v[212:215], v171, s[24:27], s51 offen sc1
    v_mfma_f32_16x16x32_bf16 v[112:115], a[44:47], v[224:227], v[112:115]
    v_mfma_f32_16x16x32_bf16 v[116:119], a[44:47], v[228:231], v[116:119]
    v_mfma_f32_16x16x32_bf16 v[120:123], a[44:47], v[232:235], v[120:123]
    v_mfma_f32_16x16x32_bf16 v[124:127], a[44:47], v[236:239], v[124:127]
    s_waitcnt vmcnt(12)
    v_mfma_f32_16x16x32_bf16 v[32:35], a[48:51], a[224:227], v[32:35]
    s_mul_i32 s51, s47, 4096
    s_add_u32 s51, s51, s46
    v_mfma_f32_16x16x32_bf16 v[36:39], a[48:51], a[228:231], v[36:39]
    s_cmp_eq_u32 s47, 13
    s_cselect_b32 s52, s50, 0
    v_mfma_f32_16x16x32_bf16 v[40:43], a[48:51], a[232:235], v[40:43]
    s_add_u32 s51, s51, s52
    s_add_u32 s47, s47, 1
    v_mfma_f32_16x16x32_bf16 v[44:47], a[48:51], a[236:239], v[44:47]
    s_cmp_eq_u32 s47, 14
    s_cselect_b32 s47, 0, s47
    v_mfma_f32_16x16x32_bf16 v[48:51], a[48:51], a[240:243], v[48:51]
    buffer_load_dwordx4 v[216:219], v166, s[24:27], s51 offen sc1
    v_mfma_f32_16x16x32_bf16 v[52:55], a[48:51], a[244:247], v[52:55]
    v_mfma_f32_16x16x32_bf16 v[56:59], a[52:55], a[224:227], v[56:59]
    v_mfma_f32_16x16x32_bf16 v[60:63], a[52:55], a[228:231], v[60:63]
    buffer_load_dwordx4 v[220:223], v167, s[24:27], s51 offen sc1
    v_mfma_f32_16x16x32_bf16 v[64:67], a[52:55], a[232:235], v[64:67]
    v_mfma_f32_16x16x32_bf16 v[68:71], a[52:55], a[236:239], v[68:71]
    v_mfma_f32_16x16x32_bf16 v[72:75], a[52:55], a[240:243], v[72:75]
    buffer_load_dwordx4 v[224:227], v168, s[24:27], s51 offen sc1
    v_mfma_f32_16x16x32_bf16 v[76:79], a[52:55], a[244:247], v[76:79]
    v_mfma_f32_16x16x32_bf16 v[80:83], a[56:59], a[224:227], v[80:83]
    v_mfma_f32_16x16x32_bf16 v[84:87], a[56:59], a[228:231], v[84:87]
    buffer_load_dwordx4 v[228:231], v169, s[24:27], s51 offen sc1
    v_mfma_f32_16x16x32_bf16 v[88:91], a[56:59], a[232:235], v[88:91]
    v_mfma_f32_16x16x32_bf16 v[92:95], a[56:59], a[236:239], v[92:95]
    v_mfma_f32_16x16x32_bf16 v[96:99], a[56:59], a[240:243], v[96:99]
    buffer_load_dwordx4 v[232:235], v170, s[24:27], s51 offen sc1
    v_mfma_f32_16x16x32_bf16 v[100:103], a[56:59], a[244:247], v[100:103]
    v_mfma_f32_16x16x32_bf16 v[104:107], a[60:63], a[224:227], v[104:107]
    v_mfma_f32_16x16x32_bf16 v[108:111], a[60:63], a[228:231], v[108:111]
    buffer_load_dwordx4 v[236:239], v171, s[24:27], s51 offen sc1
    v_mfma_f32_16x16x32_bf16 v[112:115], a[60:63], a[232:235], v[112:115]
    v_mfma_f32_16x16x32_bf16 v[116:119], a[60:63], a[236:239], v[116:119]
    v_mfma_f32_16x16x32_bf16 v[120:123], a[60:63], a[240:243], v[120:123]
    v_mfma_f32_16x16x32_bf16 v[124:127], a[60:63], a[244:247], v[124:127]
    s_waitcnt vmcnt(12)
    v_mfma_f32_16x16x32_bf16 v[32:35], a[64:67], v[128:131], v[32:35]
    s_mul_i32 s51, s47, 4096
    s_add_u32 s51, s51, s46
    v_mfma_f32_16x16x32_bf16 v[36:39], a[64:67], v[132:135], v[36:39]
    s_cmp_eq_u32 s47, 13
    s_cselect_b32 s52, s50, 0
    v_mfma_f32_16x16x32_bf16 v[40:43], a[64:67], v[136:139], v[40:43]
    s_add_u32 s51, s51, s52
    s_add_u32 s47, s47, 1
    v_mfma_f32_16x16x32_bf16 v[44:47], a[64:67], v[140:143], v[44:47]
    s_cmp_eq_u32 s47, 14
    s_cselect_b32 s47, 0, s47
    v_mfma_f32_16x16x32_bf16 v[48:51], a[64:67], v[144:147], v[48:51]
    buffer_load_dwordx4 a[224:227], v166, s[24:27], s51 offen sc1
    v_mfma_f32_16x16x32_bf16 v[52:55], a[64:67], v[148:151], v[52:55]
    v_mfma_f32_16x16x32_bf16 v[56:59], a[68:71], v[128:131], v[56:59]
    v_mfma_f32_16x16x32_bf16 v[60:63], a[68:71], v[132:135], v[60:63]
    buffer_load_dwordx4 a[228:231], v167, s[24:27], s51 offen sc1
    v_mfma_f32_16x16x32_bf16 v[64:67], a[68:71], v[136:139], v[64:67]
    v_mfma_f32_16x16x32_bf16 v[68:71], a[68:71], v[140:143], v[68:71]
    v_mfma_f32_16x16x32_bf16 v[72:75], a[68:71], v[144:147], v[72:75]
    buffer_load_dwordx4 a[232:235], v168, s[24:27], s51 offen sc1
    v_mfma_f32_16x16x32_bf16 v[76:79], a[68:71], v[148:151], v[76:79]
    v_mfma_f32_16x16x32_bf16 v[80:83], a[72:75], v[128:131], v[80:83]
    v_mfma_f32_16x16x32_bf16 v[84:87], a[72:75], v[132:135], v[84:87]
    buffer_load_dwordx4 a[236:239], v169, s[24:27], s51 offen sc1
    v_mfma_f32_16x16x32_bf16 v[88:91], a[72:75], v[136:139], v[88:91]
    v_mfma_f32_16x16x32_bf16 v[92:95], a[72:75], v[140:143], v[92:95]
    v_mfma_f32_16x16x32_bf16 v[96:99], a[72:75], v[144:147], v[96:99]
    buffer_load_dwordx4 a[240:243], v170, s[24:27], s51 offen sc1
    v_mfma_f32_16x16x32_bf16 v[100:103], a[72:75], v[148:151], v[100:103]
    v_mfma_f32_16x16x32_bf16 v[104:107], a[76:79], v[128:131], v[104:107]
    v_mfma_f32_16x16x32_bf16 v[108:111], a[76:79], v[132:135], v[108:111]
    buffer_load_dwordx4 a[244:247], v171, s[24:27], s51 offen sc1
    v_mfma_f32_16x16x32_bf16 v[112:115], a[76:79], v[136:139], v[112:115]
    v_mfma_f32_16x16x32_bf16 v[116:119], a[76:79], v[140:143], v[116:119]
    v_mfma_f32_16x16x32_bf16 v[120:123], a[76:79], v[144:147], v[120:123]
    v_mfma_f32_16x16x32_bf16 v[124:127], a[76:79], v[148:151], v[124:127]
    s_waitcnt vmcnt(12)
    v_mfma_f32_16x16x32_bf16 v[32:35], a[80:83], v[192:195], v[32:35]
    s_mul_i32 s51, s47, 4096
    s_add_u32 s51, s51, s46
    v_mfma_f32_16x16x32_bf16 v[36:39], a[80:83], v[196:199], v[36:39]
    s_cmp_eq_u32 s47, 13
    s_cselect_b32 s52, s50, 0
    v_mfma_f32_16x16x32_bf16 v[40:43], a[80:83], v[200:203], v[40:43]
    s_add_u32 s51, s51, s52
    s_add_u32 s47, s47, 1
    v_mfma_f32_16x16x32_bf16 v[44:47], a[80:83], v[204:207], v[44:47]
    s_cmp_eq_u32 s47, 14
    s_cselect_b32 s47, 0, s47
    v_mfma_f32_16x16x32_bf16 v[48:51], a[80:83], v[208:211], v[48:51]
    buffer_load_dwordx4 v[128:131], v166, s[24:27], s51 offen sc1
    v_mfma_f32_16x16x32_bf16 v[52:55], a[80:83], v[212:215], v[52:55]
    v_mfma_f32_16x16x32_bf16 v[56:59], a[84:87], v[192:195], v[56:59]
    v_mfma_f32_16x16x32_bf16 v[60:63], a[84:87], v[196:199], v[60:63]
    buffer_load_dwordx4 v[132:135], v167, s[24:27], s51 offen sc1
    v_mfma_f32_16x16x32_bf16 v[64:67], a[84:87], v[200:203], v[64:67]
    v_mfma_f32_16x16x32_bf16 v[68:71], a[84:87], v[204:207], v[68:71]
    v_mfma_f32_16x16x32_bf16 v[72:75], a[84:87], v[208:211], v[72:75]
    buffer_load_dwordx4 v[136:139], v168, s[24:27], s51 offen sc1
    v_mfma_f32_16x16x32_bf16 v[76:79], a[84:87], v[212:215], v[76:79]
    v_mfma_f32_16x16x32_bf16 v[80:83], a[88:91], v[192:195], v[80:83]
    v_mfma_f32_16x16x32_bf16 v[84:87], a[88:91], v[196:199], v[84:87]
    buffer_load_dwordx4 v[140:143], v169, s[24:27], s51 offen sc1
    v_mfma_f32_16x16x32_bf16 v[88:91], a[88:91], v[200:203], v[88:91]
    v_mfma_f32_16x16x32_bf16 v[92:95], a[88:91], v[204:207], v[92:95]
    v_mfma_f32_16x16x32_bf16 v[96:99], a[88:91], v[208:211], v[96:99]
    buffer_load_dwordx4 v[144:147], v170, s[24:27], s51 offen sc1
    v_mfma_f32_16x16x32_bf16 v[100:103], a[88:91], v[212:215], v[100:103]
    v_mfma_f32_16x16x32_bf16 v[104:107], a[92:95], v[192:195], v[104:107]
    v_mfma_f32_16x16x32_bf16 v[108:111], a[92:95], v[196:199], v[108:111]
    buffer_load_dwordx4 v[148:151], v171, s[24:27], s51 offen sc1
    v_mfma_f32_16x16x32_bf16 v[112:115], a[92:95], v[200:203], v[112:115]
    v_mfma_f32_16x16x32_bf16 v[116:119], a[92:95], v[204:207], v[116:119]
    v_mfma_f32_16x16x32_bf16 v[120:123], a[92:95], v[208:211], v[120:123]
    v_mfma_f32_16x16x32_bf16 v[124:127], a[92:95], v[212:215], v[124:127]
    s_waitcnt vmcnt(12)
    v_mfma_f32_16x16x32_bf16 v[32:35], a[96:99], v[216:219], v[32:35]
    s_mul_i32 s51, s47, 4096
    s_add_u32 s51, s51, s46
    v_mfma_f32_16x16x32_bf16 v[36:39], a[96:99], v[220:223], v[36:39]
    s_cmp_eq_u32 s47, 13
    s_cselect_b32 s52, s50, 0
    v_mfma_f32_16x16x32_bf16 v[40:43], a[96:99], v[224:227], v[40:43]
    s_add_u32 s51, s51, s52
    s_add_u32 s47, s47, 1
    v_mfma_f32_16x16x32_bf16 v[44:47], a[96:99], v[228:231], v[44:47]
    s_cmp_eq_u32 s47, 14
    s_cselect_b32 s47, 0, s47
    v_mfma_f32_16x16x32_bf16 v[48:51], a[96:99], v[232:235], v[48:51]
    buffer_load_dwordx4 v[192:195], v166, s[24:27], s51 offen sc1
    v_mfma_f32_16x16x32_bf16 v[52:55], a[96:99], v[236:239], v[52:55]
    v_mfma_f32_16x16x32_bf16 v[56:59], a[100:103], v[216:219], v[56:59]
    v_mfma_f32_16x16x32_bf16 v[60:63], a[100:103], v[220:223], v[60:63]
    buffer_load_dwordx4 v[196:199], v167, s[24:27], s51 offen sc1
    v_mfma_f32_16x16x32_bf16 v[64:67], a[100:103], v[224:227], v[64:67]
    v_mfma_f32_16x16x32_bf16 v[68:71], a[100:103], v[228:231], v[68:71]
    v_mfma_f32_16x16x32_bf16 v[72:75], a[100:103], v[232:235], v[72:75]
    buffer_load_dwordx4 v[200:203], v168, s[24:27], s51 offen sc1
    v_mfma_f32_16x16x32_bf16 v[76:79], a[100:103], v[236:239], v[76:79]
    v_mfma_f32_16x16x32_bf16 v[80:83], a[104:107], v[216:219], v[80:83]
    v_mfma_f32_16x16x32_bf16 v[84:87], a[104:107], v[220:223], v[84:87]
    buffer_load_dwordx4 v[204:207], v169, s[24:27], s51 offen sc1
    v_mfma_f32_16x16x32_bf16 v[88:91], a[104:107], v[224:227], v[88:91]
    v_mfma_f32_16x16x32_bf16 v[92:95], a[104:107], v[228:231], v[92:95]
    v_mfma_f32_16x16x32_bf16 v[96:99], a[104:107], v[232:235], v[96:99]
    buffer_load_dwordx4 v[208:211], v170, s[24:27], s51 offen sc1
    v_mfma_f32_16x16x32_bf16 v[100:103], a[104:107], v[236:239], v[100:103]
    v_mfma_f32_16x16x32_bf16 v[104:107], a[108:111], v[216:219], v[104:107]
    v_mfma_f32_16x16x32_bf16 v[108:111], a[108:111], v[220:223], v[108:111]
    buffer_load_dwordx4 v[212:215], v171, s[24:27], s51 offen sc1
    v_mfma_f32_16x16x32_bf16 v[112:115], a[108:111], v[224:227], v[112:115]
    v_mfma_f32_16x16x32_bf16 v[116:119], a[108:111], v[228:231], v[116:119]
    v_mfma_f32_16x16x32_bf16 v[120:123], a[108:111], v[232:235], v[120:123]
    v_mfma_f32_16x16x32_bf16 v[124:127], a[108:111], v[236:239], v[124:127]
    s_waitcnt vmcnt(12)
    v_mfma_f32_16x16x32_bf16 v[32:35], a[112:115], a[224:227], v[32:35]
    s_mul_i32 s51, s47, 4096
    s_add_u32 s51, s51, s46
    v_mfma_f32_16x16x32_bf16 v[36:39], a[112:115], a[228:231], v[36:39]
    s_cmp_eq_u32 s47, 13
    s_cselect_b32 s52, s50, 0
    v_mfma_f32_16x16x32_bf16 v[40:43], a[112:115], a[232:235], v[40:43]
    s_add_u32 s51, s51, s52
    s_add_u32 s47, s47, 1
    v_mfma_f32_16x16x32_bf16 v[44:47], a[112:115], a[236:239], v[44:47]
    s_cmp_eq_u32 s47, 14
    s_cselect_b32 s47, 0, s47
    v_mfma_f32_16x16x32_bf16 v[48:51], a[112:115], a[240:243], v[48:51]
    buffer_load_dwordx4 v[216:219], v166, s[24:27], s51 offen sc1
    v_mfma_f32_16x16x32_bf16 v[52:55], a[112:115], a[244:247], v[52:55]
    v_mfma_f32_16x16x32_bf16 v[56:59], a[116:119], a[224:227], v[56:59]
    v_mfma_f32_16x16x32_bf16 v[60:63], a[116:119], a[228:231], v[60:63]
    buffer_load_dwordx4 v[220:223], v167, s[24:27], s51 offen sc1
    v_mfma_f32_16x16x32_bf16 v[64:67], a[116:119], a[232:235], v[64:67]
    v_mfma_f32_16x16x32_bf16 v[68:71], a[116:119], a[236:239], v[68:71]
    v_mfma_f32_16x16x32_bf16 v[72:75], a[116:119], a[240:243], v[72:75]
    buffer_load_dwordx4 v[224:227], v168, s[24:27], s51 offen sc1
    v_mfma_f32_16x16x32_bf16 v[76:79], a[116:119], a[244:247], v[76:79]
    v_mfma_f32_16x16x32_bf16 v[80:83], a[120:123], a[224:227], v[80:83]
    v_mfma_f32_16x16x32_bf16 v[84:87], a[120:123], a[228:231], v[84:87]
    buffer_load_dwordx4 v[228:231], v169, s[24:27], s51 offen sc1
    v_mfma_f32_16x16x32_bf16 v[88:91], a[120:123], a[232:235], v[88:91]
    v_mfma_f32_16x16x32_bf16 v[92:95], a[120:123], a[236:239], v[92:95]
    v_mfma_f32_16x16x32_bf16 v[96:99], a[120:123], a[240:243], v[96:99]
    buffer_load_dwordx4 v[232:235], v170, s[24:27], s51 offen sc1
    v_mfma_f32_16x16x32_bf16 v[100:103], a[120:123], a[244:247], v[100:103]
    v_mfma_f32_16x16x32_bf16 v[104:107], a[124:127], a[224:227], v[104:107]
    v_mfma_f32_16x16x32_bf16 v[108:111], a[124:127], a[228:231], v[108:111]
    buffer_load_dwordx4 v[236:239], v171, s[24:27], s51 offen sc1
    v_mfma_f32_16x16x32_bf16 v[112:115], a[124:127], a[232:235], v[112:115]
    v_mfma_f32_16x16x32_bf16 v[116:119], a[124:127], a[236:239], v[116:119]
    v_mfma_f32_16x16x32_bf16 v[120:123], a[124:127], a[240:243], v[120:123]
    v_mfma_f32_16x16x32_bf16 v[124:127], a[124:127], a[244:247], v[124:127]
    s_waitcnt vmcnt(12)
    v_mfma_f32_16x16x32_bf16 v[32:35], a[128:131], v[128:131], v[32:35]
    s_mul_i32 s51, s47, 4096
    s_add_u32 s51, s51, s46
    v_mfma_f32_16x16x32_bf16 v[36:39], a[128:131], v[132:135], v[36:39]
    s_cmp_eq_u32 s47, 13
    s_cselect_b32 s52, s50, 0
    v_mfma_f32_16x16x32_bf16 v[40:43], a[128:131], v[136:139], v[40:43]
    s_add_u32 s51, s51, s52
    s_add_u32 s47, s47, 1
    v_mfma_f32_16x16x32_bf16 v[44:47], a[128:131], v[140:143], v[44:47]
    s_cmp_eq_u32 s47, 14
    s_cselect_b32 s47, 0, s47
    v_mfma_f32_16x16x32_bf16 v[48:51], a[128:131], v[144:147], v[48:51]
    buffer_load_dwordx4 a[224:227], v166, s[24:27], s51 offen sc1
    v_mfma_f32_16x16x32_bf16 v[52:55], a[128:131], v[148:151], v[52:55]
    v_mfma_f32_16x16x32_bf16 v[56:59], a[132:135], v[128:131], v[56:59]
    v_mfma_f32_16x16x32_bf16 v[60:63], a[132:135], v[132:135], v[60:63]
    buffer_load_dwordx4 a[228:231], v167, s[24:27], s51 offen sc1
    v_mfma_f32_16x16x32_bf16 v[64:67], a[132:135], v[136:139], v[64:67]
    v_mfma_f32_16x16x32_bf16 v[68:71], a[132:135], v[140:143], v[68:71]
    v_mfma_f32_16x16x32_bf16 v[72:75], a[132:135], v[144:147], v[72:75]
    buffer_load_dwordx4 a[232:235], v168, s[24:27], s51 offen sc1
    v_mfma_f32_16x16x32_bf16 v[76:79], a[132:135], v[148:151], v[76:79]
    v_mfma_f32_16x16x32_bf16 v[80:83], a[136:139], v[128:131], v[80:83]
    v_mfma_f32_16x16x32_bf16 v[84:87], a[136:139], v[132:135], v[84:87]
    buffer_load_dwordx4 a[236:239], v169, s[24:27], s51 offen sc1
    v_mfma_f32_16x16x32_bf16 v[88:91], a[136:139], v[136:139], v[88:91]
    v_mfma_f32_16x16x32_bf16 v[92:95], a[136:139], v[140:143], v[92:95]
    v_mfma_f32_16x16x32_bf16 v[96:99], a[136:139], v[144:147], v[96:99]
    buffer_load_dwordx4 a[240:243], v170, s[24:27], s51 offen sc1
    v_mfma_f32_16x16x32_bf16 v[100:103], a[136:139], v[148:151], v[100:103]
    v_mfma_f32_16x16x32_bf16 v[104:107], a[140:143], v[128:131], v[104:107]
    v_mfma_f32_16x16x32_bf16 v[108:111], a[140:143], v[132:135], v[108:111]
    buffer_load_dwordx4 a[244:247], v171, s[24:27], s51 offen sc1
    v_mfma_f32_16x16x32_bf16 v[112:115], a[140:143], v[136:139], v[112:115]
    v_mfma_f32_16x16x32_bf16 v[116:119], a[140:143], v[140:143], v[116:119]
    v_mfma_f32_16x16x32_bf16 v[120:123], a[140:143], v[144:147], v[120:123]
    v_mfma_f32_16x16x32_bf16 v[124:127], a[140:143], v[148:151], v[124:127]
    s_waitcnt vmcnt(12)
    v_mfma_f32_16x16x32_bf16 v[32:35], a[144:147], v[192:195], v[32:35]
    s_mul_i32 s51, s47, 4096
    s_add_u32 s51, s51, s46
    v_mfma_f32_16x16x32_bf16 v[36:39], a[144:147], v[196:199], v[36:39]
    s_cmp_eq_u32 s47, 13
    s_cselect_b32 s52, s50, 0
    v_mfma_f32_16x16x32_bf16 v[40:43], a[144:147], v[200:203], v[40:43]
    s_add_u32 s51, s51, s52
    s_add_u32 s47, s47, 1
    v_mfma_f32_16x16x32_bf16 v[44:47], a[144:147], v[204:207], v[44:47]
    s_cmp_eq_u32 s47, 14
    s_cselect_b32 s47, 0, s47
    v_mfma_f32_16x16x32_bf16 v[48:51], a[144:147], v[208:211], v[48:51]
    buffer_load_dwordx4 v[128:131], v166, s[24:27], s51 offen sc1
    v_mfma_f32_16x16x32_bf16 v[52:55], a[144:147], v[212:215], v[52:55]
    v_mfma_f32_16x16x32_bf16 v[56:59], a[148:151], v[192:195], v[56:59]
    v_mfma_f32_16x16x32_bf16 v[60:63], a[148:151], v[196:199], v[60:63]
    buffer_load_dwordx4 v[132:135], v167, s[24:27], s51 offen sc1
    v_mfma_f32_16x16x32_bf16 v[64:67], a[148:151], v[200:203], v[64:67]
    v_mfma_f32_16x16x32_bf16 v[68:71], a[148:151], v[204:207], v[68:71]
    v_mfma_f32_16x16x32_bf16 v[72:75], a[148:151], v[208:211], v[72:75]
    buffer_load_dwordx4 v[136:139], v168, s[24:27], s51 offen sc1
    v_mfma_f32_16x16x32_bf16 v[76:79], a[148:151], v[212:215], v[76:79]
    v_mfma_f32_16x16x32_bf16 v[80:83], a[152:155], v[192:195], v[80:83]
    v_mfma_f32_16x16x32_bf16 v[84:87], a[152:155], v[196:199], v[84:87]
    buffer_load_dwordx4 v[140:143], v169, s[24:27], s51 offen sc1
    v_mfma_f32_16x16x32_bf16 v[88:91], a[152:155], v[200:203], v[88:91]
    v_mfma_f32_16x16x32_bf16 v[92:95], a[152:155], v[204:207], v[92:95]
    v_mfma_f32_16x16x32_bf16 v[96:99], a[152:155], v[208:211], v[96:99]
    buffer_load_dwordx4 v[144:147], v170, s[24:27], s51 offen sc1
    v_mfma_f32_16x16x32_bf16 v[100:103], a[152:155], v[212:215], v[100:103]
    v_mfma_f32_16x16x32_bf16 v[104:107], a[156:159], v[192:195], v[104:107]
    v_mfma_f32_16x16x32_bf16 v[108:111], a[156:159], v[196:199], v[108:111]
    buffer_load_dwordx4 v[148:151], v171, s[24:27], s51 offen sc1
    v_mfma_f32_16x16x32_bf16 v[112:115], a[156:159], v[200:203], v[112:115]
    v_mfma_f32_16x16x32_bf16 v[116:119], a[156:159], v[204:207], v[116:119]
    v_mfma_f32_16x16x32_bf16 v[120:123], a[156:159], v[208:211], v[120:123]
    v_mfma_f32_16x16x32_bf16 v[124:127], a[156:159], v[212:215], v[124:127]
    s_waitcnt vmcnt(12)
    v_mfma_f32_16x16x32_bf16 v[32:35], a[160:163], v[216:219], v[32:35]
    s_mul_i32 s51, s47, 4096
    s_add_u32 s51, s51, s46
    v_mfma_f32_16x16x32_bf16 v[36:39], a[160:163], v[220:223], v[36:39]
    s_cmp_eq_u32 s47, 13
    s_cselect_b32 s52, s50, 0
    v_mfma_f32_16x16x32_bf16 v[40:43], a[160:163], v[224:227], v[40:43]
    s_add_u32 s51, s51, s52
    s_add_u32 s47, s47, 1
    v_mfma_f32_16x16x32_bf16 v[44:47], a[160:163], v[228:231], v[44:47]
    s_cmp_eq_u32 s47, 14
    s_cselect_b32 s47, 0, s47
    v_mfma_f32_16x16x32_bf16 v[48:51], a[160:163], v[232:235], v[48:51]
    buffer_load_dwordx4 v[192:195], v166, s[24:27], s51 offen sc1
    v_mfma_f32_16x16x32_bf16 v[52:55], a[160:163], v[236:239], v[52:55]
    v_mfma_f32_16x16x32_bf16 v[56:59], a[164:167], v[216:219], v[56:59]
    v_mfma_f32_16x16x32_bf16 v[60:63], a[164:167], v[220:223], v[60:63]
    buffer_load_dwordx4 v[196:199], v167, s[24:27], s51 offen sc1
    v_mfma_f32_16x16x32_bf16 v[64:67], a[164:167], v[224:227], v[64:67]
    v_mfma_f32_16x16x32_bf16 v[68:71], a[164:167], v[228:231], v[68:71]
    v_mfma_f32_16x16x32_bf16 v[72:75], a[164:167], v[232:235], v[72:75]
    buffer_load_dwordx4 v[200:203], v168, s[24:27], s51 offen sc1
    v_mfma_f32_16x16x32_bf16 v[76:79], a[164:167], v[236:239], v[76:79]
    v_mfma_f32_16x16x32_bf16 v[80:83], a[168:171], v[216:219], v[80:83]
    v_mfma_f32_16x16x32_bf16 v[84:87], a[168:171], v[220:223], v[84:87]
    buffer_load_dwordx4 v[204:207], v169, s[24:27], s51 offen sc1
    v_mfma_f32_16x16x32_bf16 v[88:91], a[168:171], v[224:227], v[88:91]
    v_mfma_f32_16x16x32_bf16 v[92:95], a[168:171], v[228:231], v[92:95]
    v_mfma_f32_16x16x32_bf16 v[96:99], a[168:171], v[232:235], v[96:99]
    buffer_load_dwordx4 v[208:211], v170, s[24:27], s51 offen sc1
    v_mfma_f32_16x16x32_bf16 v[100:103], a[168:171], v[236:239], v[100:103]
    v_mfma_f32_16x16x32_bf16 v[104:107], a[172:175], v[216:219], v[104:107]
    v_mfma_f32_16x16x32_bf16 v[108:111], a[172:175], v[220:223], v[108:111]
    buffer_load_dwordx4 v[212:215], v171, s[24:27], s51 offen sc1
    v_mfma_f32_16x16x32_bf16 v[112:115], a[172:175], v[224:227], v[112:115]
    v_mfma_f32_16x16x32_bf16 v[116:119], a[172:175], v[228:231], v[116:119]
    v_mfma_f32_16x16x32_bf16 v[120:123], a[172:175], v[232:235], v[120:123]
    v_mfma_f32_16x16x32_bf16 v[124:127], a[172:175], v[236:239], v[124:127]
    s_waitcnt vmcnt(12)
    v_mfma_f32_16x16x32_bf16 v[32:35], a[176:179], a[224:227], v[32:35]
    v_mfma_f32_16x16x32_bf16 v[36:39], a[176:179], a[228:231], v[36:39]
    v_mfma_f32_16x16x32_bf16 v[40:43], a[176:179], a[232:235], v[40:43]
    v_mfma_f32_16x16x32_bf16 v[44:47], a[176:179], a[236:239], v[44:47]
    v_mfma_f32_16x16x32_bf16 v[48:51], a[176:179], a[240:243], v[48:51]
    v_mfma_f32_16x16x32_bf16 v[52:55], a[176:179], a[244:247], v[52:55]
    v_mfma_f32_16x16x32_bf16 v[56:59], a[180:183], a[224:227], v[56:59]
    v_mfma_f32_16x16x32_bf16 v[60:63], a[180:183], a[228:231], v[60:63]
    v_mfma_f32_16x16x32_bf16 v[64:67], a[180:183], a[232:235], v[64:67]
    v_mfma_f32_16x16x32_bf16 v[68:71], a[180:183], a[236:239], v[68:71]
    v_mfma_f32_16x16x32_bf16 v[72:75], a[180:183], a[240:243], v[72:75]
    v_mfma_f32_16x16x32_bf16 v[76:79], a[180:183], a[244:247], v[76:79]
    v_mfma_f32_16x16x32_bf16 v[80:83], a[184:187], a[224:227], v[80:83]
    v_mfma_f32_16x16x32_bf16 v[84:87], a[184:187], a[228:231], v[84:87]
    v_mfma_f32_16x16x32_bf16 v[88:91], a[184:187], a[232:235], v[88:91]
    v_mfma_f32_16x16x32_bf16 v[92:95], a[184:187], a[236:239], v[92:95]
    v_mfma_f32_16x16x32_bf16 v[96:99], a[184:187], a[240:243], v[96:99]
    v_mfma_f32_16x16x32_bf16 v[100:103], a[184:187], a[244:247], v[100:103]
    v_mfma_f32_16x16x32_bf16 v[104:107], a[188:191], a[224:227], v[104:107]
    v_mfma_f32_16x16x32_bf16 v[108:111], a[188:191], a[228:231], v[108:111]
    v_mfma_f32_16x16x32_bf16 v[112:115], a[188:191], a[232:235], v[112:115]
    v_mfma_f32_16x16x32_bf16 v[116:119], a[188:191], a[236:239], v[116:119]
    v_mfma_f32_16x16x32_bf16 v[120:123], a[188:191], a[240:243], v[120:123]
    v_mfma_f32_16x16x32_bf16 v[124:127], a[188:191], a[244:247], v[124:127]
    s_waitcnt vmcnt(6)
    v_mfma_f32_16x16x32_bf16 v[32:35], a[192:195], v[128:131], v[32:35]
    v_mfma_f32_16x16x32_bf16 v[36:39], a[192:195], v[132:135], v[36:39]
    v_mfma_f32_16x16x32_bf16 v[40:43], a[192:195], v[136:139], v[40:43]
    v_mfma_f32_16x16x32_bf16 v[44:47], a[192:195], v[140:143], v[44:47]
    v_mfma_f32_16x16x32_bf16 v[48:51], a[192:195], v[144:147], v[48:51]
    v_mfma_f32_16x16x32_bf16 v[52:55], a[192:195], v[148:151], v[52:55]
    v_mfma_f32_16x16x32_bf16 v[56:59], a[196:199], v[128:131], v[56:59]
    v_mfma_f32_16x16x32_bf16 v[60:63], a[196:199], v[132:135], v[60:63]
    v_mfma_f32_16x16x32_bf16 v[64:67], a[196:199], v[136:139], v[64:67]
    v_mfma_f32_16x16x32_bf16 v[68:71], a[196:199], v[140:143], v[68:71]
    v_mfma_f32_16x16x32_bf16 v[72:75], a[196:199], v[144:147], v[72:75]
    v_mfma_f32_16x16x32_bf16 v[76:79], a[196:199], v[148:151], v[76:79]
    v_mfma_f32_16x16x32_bf16 v[80:83], a[200:203], v[128:131], v[80:83]
    v_mfma_f32_16x16x32_bf16 v[84:87], a[200:203], v[132:135], v[84:87]
    v_mfma_f32_16x16x32_bf16 v[88:91], a[200:203], v[136:139], v[88:91]
    v_mfma_f32_16x16x32_bf16 v[92:95], a[200:203], v[140:143], v[92:95]
    v_mfma_f32_16x16x32_bf16 v[96:99], a[200:203], v[144:147], v[96:99]
    v_mfma_f32_16x16x32_bf16 v[100:103], a[200:203], v[148:151], v[100:103]
    v_mfma_f32_16x16x32_bf16 v[104:107], a[204:207], v[128:131], v[104:107]
    v_mfma_f32_16x16x32_bf16 v[108:111], a[204:207], v[132:135], v[108:111]
    v_mfma_f32_16x16x32_bf16 v[112:115], a[204:207], v[136:139], v[112:115]
    v_mfma_f32_16x16x32_bf16 v[116:119], a[204:207], v[140:143], v[116:119]
    v_mfma_f32_16x16x32_bf16 v[120:123], a[204:207], v[144:147], v[120:123]
    v_mfma_f32_16x16x32_bf16 v[124:127], a[204:207], v[148:151], v[124:127]
    s_waitcnt vmcnt(0)
    v_mfma_f32_16x16x32_bf16 v[56:59], a[212:215], v[192:195], v[56:59]
    v_mfma_f32_16x16x32_bf16 v[60:63], a[212:215], v[196:199], v[60:63]
    v_mfma_f32_16x16x32_bf16 v[64:67], a[212:215], v[200:203], v[64:67]
    v_mfma_f32_16x16x32_bf16 v[68:71], a[212:215], v[204:207], v[68:71]
    v_mfma_f32_16x16x32_bf16 v[72:75], a[212:215], v[208:211], v[72:75]
    v_mfma_f32_16x16x32_bf16 v[76:79], a[212:215], v[212:215], v[76:79]
    v_mfma_f32_16x16x32_bf16 v[80:83], a[216:219], v[192:195], v[80:83]
    ds_write_b128 v174, v[56:59] offset:0
    v_mfma_f32_16x16x32_bf16 v[84:87], a[216:219], v[196:199], v[84:87]
    ds_write_b128 v174, v[60:63] offset:1024
    v_mfma_f32_16x16x32_bf16 v[88:91], a[216:219], v[200:203], v[88:91]
    ds_write_b128 v174, v[64:67] offset:2048
    v_mfma_f32_16x16x32_bf16 v[92:95], a[216:219], v[204:207], v[92:95]
    ds_write_b128 v174, v[68:71] offset:3072
    v_mfma_f32_16x16x32_bf16 v[96:99], a[216:219], v[208:211], v[96:99]
    ds_write_b128 v174, v[72:75] offset:4096
    v_mfma_f32_16x16x32_bf16 v[100:103], a[216:219], v[212:215], v[100:103]
    ds_write_b128 v174, v[76:79] offset:5120
    v_mfma_f32_16x16x32_bf16 v[104:107], a[220:223], v[192:195], v[104:107]
    ds_write_b128 v175, v[80:83] offset:0
    v_mfma_f32_16x16x32_bf16 v[108:111], a[220:223], v[196:199], v[108:111]
    ds_write_b128 v175, v[84:87] offset:1024
    v_mfma_f32_16x16x32_bf16 v[112:115], a[220:223], v[200:203], v[112:115]
    ds_write_b128 v175, v[88:91] offset:2048
    v_mfma_f32_16x16x32_bf16 v[116:119], a[220:223], v[204:207], v[116:119]
    ds_write_b128 v175, v[92:95] offset:3072
    v_mfma_f32_16x16x32_bf16 v[120:123], a[220:223], v[208:211], v[120:123]
    ds_write_b128 v175, v[96:99] offset:4096
    v_mfma_f32_16x16x32_bf16 v[124:127], a[220:223], v[212:215], v[124:127]
    ds_write_b128 v175, v[100:103] offset:5120
    v_mfma_f32_16x16x32_bf16 v[32:35], a[208:211], v[192:195], v[32:35]
    ds_write_b128 v176, v[104:107] offset:0
    v_mfma_f32_16x16x32_bf16 v[36:39], a[208:211], v[196:199], v[36:39]
    ds_write_b128 v176, v[108:111] offset:1024
    v_mfma_f32_16x16x32_bf16 v[40:43], a[208:211], v[200:203], v[40:43]
    ds_write_b128 v176, v[112:115] offset:2048
    v_mfma_f32_16x16x32_bf16 v[44:47], a[208:211], v[204:207], v[44:47]
    ds_write_b128 v176, v[116:119] offset:3072
    v_mfma_f32_16x16x32_bf16 v[48:51], a[208:211], v[208:211], v[48:51]
    ds_write_b128 v176, v[120:123] offset:4096
    v_mfma_f32_16x16x32_bf16 v[52:55], a[208:211], v[212:215], v[52:55]
    ds_write_b128 v176, v[124:127] offset:5120
    s_waitcnt lgkmcnt(0)
    s_barrier
    ds_read_b128 v[128:131], v177 offset:0
    ds_read_b128 v[132:135], v177 offset:6144
    ds_read_b128 v[136:139], v177 offset:12288
    ds_read_b128 v[140:143], v177 offset:1024
    ds_read_b128 v[144:147], v177 offset:7168
    ds_read_b128 v[148:151], v177 offset:13312
    ds_read_b128 v[152:155], v177 offset:2048
    ds_read_b128 v[156:159], v177 offset:8192
    ds_read_b128 v[192:195], v177 offset:14336
    ds_read_b128 v[196:199], v177 offset:3072
    ds_read_b128 v[200:203], v177 offset:9216
    ds_read_b128 v[204:207], v177 offset:15360
    ds_read_b128 v[208:211], v177 offset:4096
    ds_read_b128 v[212:215], v177 offset:10240
    ds_read_b128 v[216:219], v177 offset:16384
    ds_read_b128 v[220:223], v177 offset:5120
    ds_read_b128 v[224:227], v177 offset:11264
    ds_read_b128 v[228:231], v177 offset:17408
    s_waitcnt lgkmcnt(15)
    v_pk_add_f32 v[128:129], v[128:129], v[132:133]
    v_pk_add_f32 v[32:33], v[32:33], v[136:137]
    v_pk_add_f32 v[130:131], v[130:131], v[134:135]
    v_pk_add_f32 v[34:35], v[34:35], v[138:139]
    v_pk_add_f32 v[32:33], v[32:33], v[128:129]
    v_pk_add_f32 v[34:35], v[34:35], v[130:131]
    v_cvt_pk_bf16_f32 v56, v32, v33
    v_cvt_pk_bf16_f32 v57, v34, v35
    s_mov_b32 s51, 0
    buffer_store_dwordx2 v[56:57], v178, s[28:31], s51 offen
    s_waitcnt lgkmcnt(12)
    v_pk_add_f32 v[140:141], v[140:141], v[144:145]
    v_pk_add_f32 v[36:37], v[36:37], v[148:149]
    v_pk_add_f32 v[142:143], v[142:143], v[146:147]
    v_pk_add_f32 v[38:39], v[38:39], v[150:151]
    v_pk_add_f32 v[36:37], v[36:37], v[140:141]
    v_pk_add_f32 v[38:39], v[38:39], v[142:143]
    v_cvt_pk_bf16_f32 v58, v36, v37
    v_cvt_pk_bf16_f32 v59, v38, v39
    s_mov_b32 s51, 20480
    buffer_store_dwordx2 v[58:59], v178, s[28:31], s51 offen
    s_waitcnt lgkmcnt(9)
    v_pk_add_f32 v[152:153], v[152:153], v[156:157]
    v_pk_add_f32 v[40:41], v[40:41], v[192:193]
    v_pk_add_f32 v[154:155], v[154:155], v[158:159]
    v_pk_add_f32 v[42:43], v[42:43], v[194:195]
    v_pk_add_f32 v[40:41], v[40:41], v[152:153]
    v_pk_add_f32 v[42:43], v[42:43], v[154:155]
    v_cvt_pk_bf16_f32 v60, v40, v41
    v_cvt_pk_bf16_f32 v61, v42, v43
    s_mov_b32 s51, 40960
    buffer_store_dwordx2 v[60:61], v178, s[28:31], s51 offen
    s_waitcnt lgkmcnt(6)
    v_pk_add_f32 v[196:197], v[196:197], v[200:201]
    v_pk_add_f32 v[44:45], v[44:45], v[204:205]
    v_pk_add_f32 v[198:199], v[198:199], v[202:203]
    v_pk_add_f32 v[46:47], v[46:47], v[206:207]
    v_pk_add_f32 v[44:45], v[44:45], v[196:197]
    v_pk_add_f32 v[46:47], v[46:47], v[198:199]
    v_cvt_pk_bf16_f32 v62, v44, v45
    v_cvt_pk_bf16_f32 v63, v46, v47
    s_mov_b32 s51, 61440
    buffer_store_dwordx2 v[62:63], v178, s[28:31], s51 offen
    s_waitcnt lgkmcnt(3)
    v_pk_add_f32 v[208:209], v[208:209], v[212:213]
    v_pk_add_f32 v[48:49], v[48:49], v[216:217]
    v_pk_add_f32 v[210:211], v[210:211], v[214:215]
    v_pk_add_f32 v[50:51], v[50:51], v[218:219]
    v_pk_add_f32 v[48:49], v[48:49], v[208:209]
    v_pk_add_f32 v[50:51], v[50:51], v[210:211]
    v_cvt_pk_bf16_f32 v64, v48, v49
    v_cvt_pk_bf16_f32 v65, v50, v51
    s_mov_b32 s51, 81920
    buffer_store_dwordx2 v[64:65], v178, s[28:31], s51 offen
    s_waitcnt lgkmcnt(0)
    v_pk_add_f32 v[220:221], v[220:221], v[224:225]
    v_pk_add_f32 v[52:53], v[52:53], v[228:229]
    v_pk_add_f32 v[222:223], v[222:223], v[226:227]
    v_pk_add_f32 v[54:55], v[54:55], v[230:231]
    v_pk_add_f32 v[52:53], v[52:53], v[220:221]
    v_pk_add_f32 v[54:55], v[54:55], v[222:223]
    v_cvt_pk_bf16_f32 v66, v52, v53
    v_cvt_pk_bf16_f32 v67, v54, v55
    s_mov_b32 s51, 102400
    buffer_store_dwordx2 v[66:67], v178, s[28:31], s51 offen
    s_endpgm
Lexitw:
    s_waitcnt vmcnt(0)
Lexit:
    s_endpgm
.section .rodata,"a"
.p2align 6
.amdhsa_kernel standalone__dense_activation_relu__prompt_kernel
  .amdhsa_next_free_vgpr 512
  .amdhsa_next_free_sgpr 102
  .amdhsa_accum_offset 256
  .amdhsa_group_segment_fixed_size 0
  .amdhsa_kernarg_size 48
  .amdhsa_user_sgpr_count 2
  .amdhsa_user_sgpr_kernarg_segment_ptr 1
  .amdhsa_system_sgpr_workgroup_id_x 1
.end_amdhsa_kernel
```
